```python
import torch

def _softmax(x, axis=-1):
    return torch.softmax(x, dim=axis)
def _gelu(x):
    return torch.nn.functional.gelu(x, approximate="tanh")
def _silu(x):
    return torch.nn.functional.silu(x)
def _sigmoid(x):
    return torch.sigmoid(x)
def _layernorm(x, axis=-1, eps=1e-5):
    m = x.mean(dim=axis, keepdim=True)
    v = x.var(dim=axis, keepdim=True, unbiased=False)
    return (x - m) / torch.sqrt(v + eps)
def _scatter_add(tgt, idx, src, axis=0):
    return tgt.clone().index_add_(axis, idx, src)
def _segment_sum(src, seg, n):
    out = torch.zeros((n,) + src.shape[1:], dtype=src.dtype)
    return out.index_add_(0, seg, src)
def _pad(x, pw):
    flat = tuple(v for pair in reversed(pw) for v in pair)
    return torch.nn.functional.pad(x, flat)

kernel_name = 'recurrent_scan__ssm_conv_s4d__swiglu_ffn__prompt'

def setup_inputs():

    _w = (lambda a: (lambda t: t.to(torch.bfloat16) if t.is_floating_point() else t)(torch.as_tensor(a)))
    def _A_setup():
        Bsz, L, D, N = 1, 2048, 512, 128
        return {
            "u": _w((lambda *s: torch.randn(*s, dtype=torch.bfloat16) * 0.05)(Bsz, L, D)),
            "log_A_real": _w((lambda *s: torch.randn(*s, dtype=torch.bfloat16) * 6.4)(D, N) * 0.5),
            "A_imag": _w((lambda *s: torch.randn(*s, dtype=torch.bfloat16) * 0.05)(D, N) * 3.14),
            "C_real": _w((lambda *s: torch.randn(*s, dtype=torch.bfloat16) * 0.05)(D, N) / N ** 0.5),
            "C_imag": _w((lambda *s: torch.randn(*s, dtype=torch.bfloat16) * 0.05)(D, N) / N ** 0.5),
            "log_dt": _w((lambda *s: torch.randn(*s, dtype=torch.bfloat16) * 0.05)(D) * 0.5 - 4.0),
            "D_skip": _w((lambda *s: torch.randn(*s, dtype=torch.bfloat16) * 0.05)(D)),
        }
    _A_in = _A_setup()

    def _B_setup():
        B, S, D, F = 1, 2048, 512, 1376
        return {
            "x": _w((lambda *s: torch.randn(*s, dtype=torch.bfloat16) * 0.05)(B, S, D)),
            "w_gate": _w((lambda *s: torch.randn(*s, dtype=torch.bfloat16) * 0.05)(D, F)),
            "w_up": _w((lambda *s: torch.randn(*s, dtype=torch.bfloat16) * 0.05)(D, F)),
            "w_down": _w((lambda *s: torch.randn(*s, dtype=torch.bfloat16) * 0.05)(F, D)),
        }
    _B_in = _B_setup()

    return {
        "A_u": _A_in["u"],
        "A_log_A_real": _A_in["log_A_real"],
        "A_A_imag": _A_in["A_imag"],
        "A_C_real": _A_in["C_real"],
        "A_C_imag": _A_in["C_imag"],
        "A_log_dt": _A_in["log_dt"],
        "A_D_skip": _A_in["D_skip"],
        "B_x": _B_in["x"],
        "B_w_gate": _B_in["w_gate"],
        "B_w_up": _B_in["w_up"],
        "B_w_down": _B_in["w_down"],
    }

def reference(A_u, A_log_A_real, A_A_imag, A_C_real, A_C_imag, A_log_dt, A_D_skip, B_x, B_w_gate, B_w_up, B_w_down):
    def _A_ref(u, log_A_real, A_imag, C_real, C_imag, log_dt, D_skip):
        L = u.shape[1]
        dt = torch.exp(log_dt)
        A = -torch.exp(log_A_real) + 1j * A_imag
        C = (C_real + 1j * C_imag) * dt[:, None]
        pos = (lambda x, dt: x.to(dt))(torch.arange(L), log_dt.dtype)
        P = torch.exp((A * dt[:, None])[:, :, None] * pos[None, None, :])
        K = 2.0 * torch.einsum("dn,dnl->dl", C, P).real
        L2 = 2 * L
        u_t = (lambda x, *d: x.permute(*d))(u, 0, 2, 1)
        Kf = (lambda x, *a, **k: torch.fft.rfft(x.float(), *a, **k))(K, L2)
        Uf = (lambda x, *a, **k: torch.fft.rfft(x.float(), *a, **k))(u_t, L2)
        y = (lambda x, *a, **k: torch.fft.irfft(x, *a, **k).to(torch.bfloat16))(Uf * Kf[None, :, :], L2)[:, :, :L]
        y = (lambda x, *d: x.permute(*d))(y, 0, 2, 1)
        return y + u * D_skip[None, None, :]

    def _B_ref(x, w_gate, w_up, w_down):
        g = _silu(x @ w_gate)
        u = x @ w_up
        return (g * u) @ w_down

    x = A_u
    xn = _layernorm(x, axis=-1)
    s = _A_ref(xn, A_log_A_real, A_A_imag, A_C_real, A_C_imag, A_log_dt, A_D_skip)
    g = _silu(_B_ref(xn, B_w_gate, B_w_up, B_w_down))
    return x + s * g
```

```asm
; @launch grid=(256,1,1) block=(512,1,1) lds=159232
.amdgcn_target "amdgcn-amd-amdhsa--gfx950"
.text
.globl recurrent_scan__ssm_conv_s4d__swiglu_ffn__prompt_kernel
.p2align 8
.type recurrent_scan__ssm_conv_s4d__swiglu_ffn__prompt_kernel,@function
recurrent_scan__ssm_conv_s4d__swiglu_ffn__prompt_kernel:
    s_cmp_ge_u32 s2, 256
    s_cbranch_scc1 L_exit
    v_lshrrev_b32 v1, 6, v0
    v_and_b32 v0, 63, v0
    v_readfirstlane_b32 s3, v1
    v_mov_b32 v15, 157696
    s_xor_b32 s3, s3, 0
    s_cmp_lg_u32 s3, 5
    s_cbranch_scc1 L_noinit
    v_mov_b32 v2, 0
    v_lshl_add_u32 v3, v0, 2, v15
    ds_write_b32 v3, v2
    s_getpc_b64 s[56:57]
L_pc:
    s_lshr_b32 s58, s2, 3
    s_lshl_b32 s58, s58, 10
    v_lshl_add_u32 v3, v0, 7, s58
    v_min_u32 v3, L_codeend-L_pc-4, v3
    s_mov_b64 exec, 0xff
    global_load_dword v255, v3, s[56:57]
    s_mov_b64 exec, -1
    s_waitcnt lgkmcnt(0)
L_noinit:
    s_load_dwordx16 s[8:23], s[0:1], 0
    s_load_dwordx8 s[24:31], s[0:1], 64
    s_load_dwordx2 s[34:35], s[0:1], 104
    s_and_b32 s4, s2, 7
    s_lshr_b32 s5, s2, 3
    s_and_b32 s6, s5, 1
    s_lshl_b32 s7, s4, 1
    s_add_u32 s6, s6, s7
    s_lshr_b32 s7, s5, 1
    s_cmp_eq_u32 s7, 15
    s_cselect_b32 s7, s6, s7
    s_cselect_b32 s32, 1, 0
    s_lshl_b32 s53, s4, 5
    s_add_u32 s53, s53, s5
    s_and_b32 s33, s5, 3
    s_lshl_b32 s57, s4, 2
    s_add_u32 s33, s33, s57
    s_mov_b32 s55, 200000
    s_barrier
    s_cmp_ge_u32 s3, 6
    s_cbranch_scc1 L_loader
    s_cmp_ge_u32 s3, 4
    s_cbranch_scc1 L_p47
    s_and_b32 s60, s3, 1
    s_lshr_b32 s61, s3, 1
    s_lshl_b32 s56, s53, 1
    s_add_u32 s56, s56, s61
    s_lshl_b32 s57, s56, 8
    s_lshl_b32 s58, s60, 7
    s_add_u32 s57, s57, s58
    v_lshl_add_u32 v16, v0, 1, s57
    s_lshl_b32 s57, s56, 1
    v_mov_b32 v17, s57
    s_waitcnt lgkmcnt(0)
    s_mov_b32 s40, s34
    s_and_b32 s41, s35, 0xffff
    s_mov_b32 s42, 268435456
    s_mov_b32 s43, 0x00020000
    global_load_short_d16_hi v20, v16, s[10:11] nt
    global_load_short_d16_hi v21, v17, s[18:19]
    global_load_short_d16_hi v22, v16, s[12:13] nt
    global_load_short_d16_hi v24, v16, s[14:15] nt
    global_load_short_d16_hi v25, v16, s[16:17] nt
    s_branch L_gemm
L_p47:
    s_sub_u32 s54, s3, 4
    s_lshl_b32 s46, s53, 13
    s_lshl_b32 s58, s54, 12
    s_add_u32 s46, s46, s58
    v_lshlrev_b32 v2, 4, v0
    s_lshl_b32 s56, s53, 1
    s_add_u32 s56, s56, s54
    s_lshl_b32 s57, s56, 1
    v_mov_b32 v3, s57
    v_mov_b32 v13, 0
    s_waitcnt lgkmcnt(0)
    s_mov_b32 s40, s34
    s_and_b32 s41, s35, 0xffff
    s_mov_b32 s42, 268435456
    s_mov_b32 s43, 0x00020000
    s_mov_b32 s36, s8
    s_and_b32 s37, s9, 0xffff
    s_mov_b32 s38, 2097152
    s_mov_b32 s39, 0x00020000
    buffer_load_dwordx4 v[128:131], v2, s[36:39], s46 offen offset:0 nt
    buffer_load_dwordx4 v[132:135], v2, s[36:39], s46 offen offset:1024 nt
    buffer_load_dwordx4 v[136:139], v2, s[36:39], s46 offen offset:2048 nt
    buffer_load_dwordx4 v[140:143], v2, s[36:39], s46 offen offset:3072 nt
    global_load_ushort v9, v3, s[20:21]
    buffer_load_dword v14, v13, s[40:43], 0 offen sc1
    s_branch L_kgen
L_loader:
    s_sub_u32 s54, s3, 6
    v_lshrrev_b32 v3, 2, v0
    v_mul_u32_u24 v3, 2752, v3
    v_and_b32 v11, 3, v0
    v_lshrrev_b32 v1, 5, v0
    v_lshlrev_b32 v1, 1, v1
    v_xor_b32 v7, v1, v11
    v_lshl_add_u32 v7, v7, 4, v3
    v_lshrrev_b32 v1, 3, v0
    v_lshlrev_b32 v2, 10, v1
    v_and_b32 v5, 7, v0
    v_lshrrev_b32 v6, 4, v0
    s_lshl_b32 s56, s54, 2
    v_add_u32 v6, s56, v6
    v_xor_b32 v6, v5, v6
    v_lshl_add_u32 v6, v6, 4, v2
    v_add_u32 v9, s56, v15
    v_lshl_add_u32 v11, v11, 2, v15
    v_mov_b32 v10, 0
    v_mov_b32 v16, 0
    v_lshlrev_b32 v14, 7, v0
    s_lshl_b32 s64, s6, 17
    s_lshl_b32 s56, s54, 13
    s_add_u32 s64, s64, s56
    s_mul_i32 s50, s7, 192
    s_cmp_eq_u32 s7, 14
    s_cselect_b32 s52, 0x40000000, 0
    s_lshl_b32 s59, s54, 10
    s_mul_i32 s60, s54, 12288
    s_add_u32 s60, s60, 16384
    s_mov_b32 s61, 0
    s_mov_b32 s62, 0
    s_mov_b32 s66, 0
    s_mov_b32 s38, 2097152
    s_mov_b32 s39, 0x00020000
    s_mov_b32 s46, 1409024
    s_mov_b32 s47, 0x00020000
    s_cmp_eq_u32 s54, 1
    s_waitcnt lgkmcnt(0)
    s_cselect_b32 s44, s26, s24
    s_cselect_b32 s45, s27, s25
    s_mov_b32 s36, s8
    s_and_b32 s37, s9, 0xffff
    s_and_b32 s45, s45, 0xffff
    s_cmp_eq_u32 s32, 1
    s_cbranch_scc1 L_lc
    s_branch L_ld_is
L_ld_st:
Lv1:
    s_waitcnt lgkmcnt(0)
    v_cmp_gt_u32 vcc, s66, v16
    s_nop 0
    s_cbranch_vccz Lv1d
    s_sleep 1
    ds_read_b32 v16, v11 offset:16
    s_sub_u32 s55, s55, 1
    s_max_i32 s55, s55, 0
    s_cmp_lg_u32 s55, 0
    s_cbranch_scc1 Lv1
Lv1d:
L_ld_is:
    s_add_u32 s65, s62, s59
    s_add_u32 s51, s50, s52
    s_add_u32 s49, s62, s60
    s_add_u32 m0, s65, 10240
    s_add_u32 s56, s64, 81920
    buffer_load_dwordx4 v6, s[36:39], s56 offen lds
    s_add_u32 m0, s65, 12288
    s_add_u32 s56, s64, 98304
    buffer_load_dwordx4 v6, s[36:39], s56 offen lds
    s_add_u32 m0, s65, 14336
    s_add_u32 s56, s64, 114688
    buffer_load_dwordx4 v6, s[36:39], s56 offen lds
    s_add_u32 m0, s49, 0
    s_add_u32 s56, s50, 0
    buffer_load_dwordx4 v7, s[44:47], s56 offen lds
    s_add_u32 m0, s49, 4096
    s_add_u32 s56, s51, 64
    buffer_load_dwordx4 v7, s[44:47], s56 offen lds
    s_add_u32 m0, s49, 8192
    s_add_u32 s56, s51, 128
    buffer_load_dwordx4 v7, s[44:47], s56 offen lds
    s_add_u32 m0, s49, 1024
    s_add_u32 s56, s50, 44032
    buffer_load_dwordx4 v7, s[44:47], s56 offen lds
    s_add_u32 m0, s49, 5120
    s_add_u32 s56, s51, 44096
    buffer_load_dwordx4 v7, s[44:47], s56 offen lds
    s_add_u32 m0, s49, 9216
    s_add_u32 s56, s51, 44160
    buffer_load_dwordx4 v7, s[44:47], s56 offen lds
    s_add_u32 m0, s49, 2048
    s_add_u32 s56, s50, 88064
    buffer_load_dwordx4 v7, s[44:47], s56 offen lds
    s_waitcnt vmcnt(10)
    ds_write_b32 v9, v10
    s_cmp_gt_u32 s61, 1
    s_cbranch_scc1 L_ld_nw
    s_cmp_eq_u32 s61, 1
    s_cbranch_scc1 L_ld_w1
    s_mul_i32 s56, s2, 4864
    s_add_u32 s56, s56, 176128
    s_mov_b32 exec_hi, 0x3f
    buffer_load_dword v13, v14, s[44:47], s56 offen
    s_mov_b64 exec, -1
    s_branch L_ld_nw
L_ld_w1:
    s_mov_b32 s20, s28
    s_and_b32 s21, s29, 0xffff
    s_mov_b32 s22, 1409024
    s_mov_b32 s23, 0x00020000
    s_lshl_b32 s56, s7, 4
    s_add_u32 s56, s56, s6
    s_lshl_b32 s56, s56, 1
    s_add_u32 s56, s56, s54
    s_mul_i32 s56, s56, 2944
    s_mov_b64 exec, 0x7fffff
    buffer_load_dword v13, v14, s[20:23], s56 offen
    s_mov_b64 exec, -1
L_ld_nw:
    s_add_u32 m0, s49, 6144
    s_add_u32 s56, s51, 88128
    buffer_load_dwordx4 v7, s[44:47], s56 offen lds
    s_add_u32 m0, s49, 10240
    s_add_u32 s56, s51, 88192
    buffer_load_dwordx4 v7, s[44:47], s56 offen lds
    s_add_u32 m0, s49, 3072
    s_add_u32 s56, s50, 132096
    buffer_load_dwordx4 v7, s[44:47], s56 offen lds
    s_add_u32 m0, s49, 7168
    s_add_u32 s56, s51, 132160
    buffer_load_dwordx4 v7, s[44:47], s56 offen lds
    v_add_u32 v10, 1, v10
    ds_read_b32 v16, v11 offset:16
    s_add_u32 m0, s49, 11264
    s_add_u32 s56, s51, 132224
    buffer_load_dwordx4 v7, s[44:47], s56 offen lds
    s_cmp_lg_u32 s61, 2
    s_cbranch_scc1 L_ld_nb
Lw2:
    ds_read_b64 v[18:19], v15 offset:128
    s_waitcnt lgkmcnt(0)
    v_min_u32 v18, v18, v19
    s_nop 0
    v_readfirstlane_b32 s67, v18
    s_nop 0
    s_cmp_lg_u32 s67, 0
    s_cbranch_scc1 Lw2d
    s_sleep 1
    s_sub_u32 s55, s55, 1
    s_max_i32 s55, s55, 0
    s_cmp_lg_u32 s55, 0
    s_cbranch_scc1 Lw2
Lw2d:
L_ld_nb:
    s_add_u32 m0, s65, 0
    s_add_u32 s56, s64, 0
    buffer_load_dwordx4 v6, s[36:39], s56 offen lds
    s_add_u32 m0, s65, 2048
    s_add_u32 s56, s64, 16384
    buffer_load_dwordx4 v6, s[36:39], s56 offen lds
    s_add_u32 m0, s65, 4096
    s_add_u32 s56, s64, 32768
    buffer_load_dwordx4 v6, s[36:39], s56 offen lds
    s_add_u32 m0, s65, 6144
    s_add_u32 s56, s64, 49152
    buffer_load_dwordx4 v6, s[36:39], s56 offen lds
    s_add_u32 m0, s65, 8192
    s_add_u32 s56, s64, 65536
    buffer_load_dwordx4 v6, s[36:39], s56 offen lds
    s_add_u32 s64, s64, 128
    s_add_u32 s50, s50, 176128
    s_sub_i32 s66, s61, 1
    s_max_i32 s66, s66, 0
    s_add_u32 s61, s61, 1
    s_add_u32 s62, s62, 40960
    s_cmp_eq_u32 s62, 122880
    s_cselect_b32 s62, 0, s62
    s_cmp_lt_u32 s61, 8
    s_cbranch_scc1 L_ld_st
L_ld_e:
    s_setprio 3
    s_mov_b32 s64, s66
    s_and_b32 s66, s3, 1
    s_bfe_u32 s48, s3, 0x10001
    v_and_b32 v125, 31, v0
    v_lshrrev_b32 v117, 5, v0
    v_bfe_u32 v118, v0, 2, 2
    v_lshl_add_u32 v118, v117, 3, v118
    v_lshlrev_b32 v116, 7, v118
    v_bfe_u32 v118, v0, 3, 1
    v_lshl_add_u32 v116, v118, 6, v116
    v_bfe_u32 v118, v0, 4, 1
    v_lshl_add_u32 v116, v118, 5, v116
    v_and_b32 v118, 3, v0
    v_lshl_add_u32 v116, v118, 3, v116
    s_mul_i32 s101, s48, 20480
    v_add_u32 v116, s101, v116
    v_xor_b32 v117, 64, v116
    v_add_u32 v118, 81920, v116
    v_add_u32 v119, 81920, v117
    s_lshl_b32 s67, s48, 2
    v_add_u32 v120, s67, v15
    v_lshlrev_b32 v121, 4, v0
    s_and_b32 s67, s3, 3
    s_lshl_b32 s67, s67, 2
    v_add_u32 v122, s67, v15
    v_xor_b32 v123, 4, v122
    s_lshl_b32 s67, s66, 13
    s_add_u32 s101, s101, s67
    s_add_u32 s101, s101, 40960
    v_add_u32 v124, s101, v121
    v_min_u32 v125, 28, v125
    v_lshlrev_b32 v125, 2, v125
    v_add_u32 v126, 4096, v125
    v_and_b32 v127, 1, v0
    s_lshl_b32 s67, s66, 3
    v_lshl_add_u32 v127, v127, 2, s67
    v_add_u32 v127, v127, v15
    v_mov_b32 v114, 1
    v_mov_b32 v115, 2
    s_lshl_b32 s101, s33, 1
    s_add_u32 s101, s101, s66
    s_mul_i32 s101, s101, 88064
    s_mul_i32 s67, s48, 44032
    s_add_u32 s101, s101, s67
    s_add_u32 s101, s101, 6356992
    s_lshl_b32 s48, s33, 7
    s_add_u32 s48, s48, 12288
    s_mov_b32 s40, s34
    s_and_b32 s41, s35, 0xffff
    s_mov_b32 s42, 268435456
    s_mov_b32 s43, 0x00020000
    s_mov_b32 s20, s28
    s_and_b32 s21, s29, 0xffff
    s_mov_b32 s22, 1409024
    s_mov_b32 s23, 0x00020000
    s_mov_b32 s66, s64
    v_and_b32 v8, 2, v1
    v_lshlrev_b32 v8, 1, v8
    v_xor_b32 v8, v5, v8
    v_lshl_add_u32 v8, v8, 4, v2
    s_lshr_b32 s57, s5, 2
    s_xor_b32 s57, s57, 4
    s_lshl_b32 s57, s57, 7
    s_mul_i32 s58, s54, 704512
    s_add_u32 s57, s57, s58
    s_mul_i32 s59, s54, 20480
    s_waitcnt vmcnt(0)
    ds_write_b32 v9, v10
L_ld_wc:
Lv3:
    s_waitcnt lgkmcnt(0)
    v_cmp_gt_u32 vcc, s66, v16
    s_nop 0
    s_cbranch_vccz Lv3d
    s_sleep 1
    ds_read_b32 v16, v11 offset:16
    s_sub_u32 s55, s55, 1
    s_max_i32 s55, s55, 0
    s_cmp_lg_u32 s55, 0
    s_cbranch_scc1 Lv3
Lv3d:
    s_add_u32 s65, s62, s59
    s_add_u32 m0, s65, 0
    s_add_u32 s56, s57, 0
    buffer_load_dwordx4 v8, s[20:23], s56 offen lds
    s_add_u32 m0, s65, 1024
    s_add_u32 s56, s57, 8192
    buffer_load_dwordx4 v8, s[20:23], s56 offen lds
    s_add_u32 m0, s65, 2048
    s_add_u32 s56, s57, 16384
    buffer_load_dwordx4 v8, s[20:23], s56 offen lds
    s_add_u32 m0, s65, 3072
    s_add_u32 s56, s57, 24576
    buffer_load_dwordx4 v8, s[20:23], s56 offen lds
    s_add_u32 m0, s65, 4096
    s_add_u32 s56, s57, 32768
    buffer_load_dwordx4 v8, s[20:23], s56 offen lds
    s_add_u32 m0, s65, 5120
    s_add_u32 s56, s57, 40960
    buffer_load_dwordx4 v8, s[20:23], s56 offen lds
    s_add_u32 m0, s65, 6144
    s_add_u32 s56, s57, 49152
    buffer_load_dwordx4 v8, s[20:23], s56 offen lds
    s_add_u32 m0, s65, 7168
    s_add_u32 s56, s57, 57344
    buffer_load_dwordx4 v8, s[20:23], s56 offen lds
    s_add_u32 m0, s65, 8192
    s_add_u32 s56, s57, 65536
    buffer_load_dwordx4 v8, s[20:23], s56 offen lds
    s_add_u32 m0, s65, 9216
    s_add_u32 s56, s57, 73728
    buffer_load_dwordx4 v8, s[20:23], s56 offen lds
    s_waitcnt vmcnt(10)
    ds_write_b32 v9, v10
    s_add_u32 m0, s65, 10240
    s_add_u32 s56, s57, 81920
    buffer_load_dwordx4 v8, s[20:23], s56 offen lds
    s_add_u32 m0, s65, 11264
    s_add_u32 s56, s57, 90112
    buffer_load_dwordx4 v8, s[20:23], s56 offen lds
    s_add_u32 m0, s65, 12288
    s_add_u32 s56, s57, 98304
    buffer_load_dwordx4 v8, s[20:23], s56 offen lds
    s_add_u32 m0, s65, 13312
    s_add_u32 s56, s57, 106496
    buffer_load_dwordx4 v8, s[20:23], s56 offen lds
    s_add_u32 m0, s65, 14336
    s_add_u32 s56, s57, 114688
    buffer_load_dwordx4 v8, s[20:23], s56 offen lds
    s_add_u32 m0, s65, 15360
    s_add_u32 s56, s57, 122880
    buffer_load_dwordx4 v8, s[20:23], s56 offen lds
    v_add_u32 v10, 1, v10
    ds_read_b32 v16, v11 offset:16
    s_add_u32 m0, s65, 16384
    s_add_u32 s56, s57, 131072
    buffer_load_dwordx4 v8, s[20:23], s56 offen lds
    s_add_u32 m0, s65, 17408
    s_add_u32 s56, s57, 139264
    buffer_load_dwordx4 v8, s[20:23], s56 offen lds
    s_add_u32 m0, s65, 18432
    s_add_u32 s56, s57, 147456
    buffer_load_dwordx4 v8, s[20:23], s56 offen lds
    s_add_u32 m0, s65, 19456
    s_add_u32 s56, s57, 155648
    buffer_load_dwordx4 v8, s[20:23], s56 offen lds
    s_add_u32 s57, s57, 163840
    s_sub_i32 s66, s61, 1
    s_max_i32 s66, s66, 0
    s_add_u32 s61, s61, 1
    s_add_u32 s62, s62, 40960
    s_cmp_eq_u32 s62, 122880
    s_cselect_b32 s62, 0, s62
    s_cmp_lt_u32 s61, 11
    s_cbranch_scc1 L_ld_wc
    s_branch L_g2
L_lc:
    s_add_u32 s50, s50, 1232896
    s_cmp_eq_u32 s7, 15
    s_cselect_b32 s50, 0x40000000, s50
L_lc_st:
Lv4:
    s_waitcnt lgkmcnt(0)
    v_cmp_gt_u32 vcc, s66, v16
    s_nop 0
    s_cbranch_vccz Lv4d
    s_sleep 1
    ds_read_b32 v16, v11 offset:16
    s_sub_u32 s55, s55, 1
    s_max_i32 s55, s55, 0
    s_cmp_lg_u32 s55, 0
    s_cbranch_scc1 Lv4
Lv4d:
    s_add_u32 s51, s50, s52
    s_add_u32 s49, s62, s60
    s_add_u32 m0, s49, 0
    s_add_u32 s56, s50, 0
    buffer_load_dwordx4 v7, s[44:47], s56 offen lds
    s_add_u32 m0, s49, 4096
    s_add_u32 s56, s51, 64
    buffer_load_dwordx4 v7, s[44:47], s56 offen lds
    s_add_u32 m0, s49, 8192
    s_add_u32 s56, s51, 128
    buffer_load_dwordx4 v7, s[44:47], s56 offen lds
    s_add_u32 m0, s49, 1024
    s_add_u32 s56, s50, 44032
    buffer_load_dwordx4 v7, s[44:47], s56 offen lds
    s_add_u32 m0, s49, 5120
    s_add_u32 s56, s51, 44096
    buffer_load_dwordx4 v7, s[44:47], s56 offen lds
    s_add_u32 m0, s49, 9216
    s_add_u32 s56, s51, 44160
    buffer_load_dwordx4 v7, s[44:47], s56 offen lds
    s_add_u32 m0, s49, 2048
    s_add_u32 s56, s50, 88064
    buffer_load_dwordx4 v7, s[44:47], s56 offen lds
    s_add_u32 m0, s49, 6144
    s_add_u32 s56, s51, 88128
    buffer_load_dwordx4 v7, s[44:47], s56 offen lds
    s_waitcnt vmcnt(8)
    ds_write_b32 v9, v10
    s_cmp_lg_u32 s61, 0
    s_cbranch_scc1 L_lc_nw
    s_mul_i32 s56, s2, 4864
    s_add_u32 s56, s56, 176128
    s_mov_b32 exec_hi, 0x3f
    buffer_load_dword v13, v14, s[44:47], s56 offen
    s_mov_b64 exec, -1
L_lc_nw:
    s_add_u32 m0, s49, 10240
    s_add_u32 s56, s51, 88192
    buffer_load_dwordx4 v7, s[44:47], s56 offen lds
    v_add_u32 v10, 1, v10
    ds_read_b32 v16, v11 offset:16
    s_add_u32 m0, s49, 3072
    s_add_u32 s56, s50, 132096
    buffer_load_dwordx4 v7, s[44:47], s56 offen lds
    s_add_u32 m0, s49, 7168
    s_add_u32 s56, s51, 132160
    buffer_load_dwordx4 v7, s[44:47], s56 offen lds
    s_add_u32 m0, s49, 11264
    s_add_u32 s56, s51, 132224
    buffer_load_dwordx4 v7, s[44:47], s56 offen lds
    s_sub_u32 s50, s50, 176128
    s_sub_i32 s66, s61, 1
    s_max_i32 s66, s66, 0
    s_add_u32 s61, s61, 1
    s_add_u32 s62, s62, 40960
    s_cmp_eq_u32 s62, 122880
    s_cselect_b32 s62, 0, s62
    s_cmp_lt_u32 s61, 8
    s_cbranch_scc1 L_lc_st
Lw5:
    ds_read_b64 v[18:19], v15 offset:128
    s_waitcnt lgkmcnt(0)
    v_min_u32 v18, v18, v19
    s_nop 0
    v_readfirstlane_b32 s67, v18
    s_nop 0
    s_cmp_lg_u32 s67, 0
    s_cbranch_scc1 Lw5d
    s_sleep 1
    s_sub_u32 s55, s55, 1
    s_max_i32 s55, s55, 0
    s_cmp_lg_u32 s55, 0
    s_cbranch_scc1 Lw5
Lw5d:
    s_waitcnt vmcnt(0)
    ds_write_b32 v9, v10
Lw6:
    ds_read_b64 v[18:19], v15 offset:136
    s_waitcnt lgkmcnt(0)
    v_min_u32 v18, v18, v19
    s_nop 0
    v_readfirstlane_b32 s67, v18
    s_nop 0
    s_cmp_lg_u32 s67, 0
    s_cbranch_scc1 Lw6d
    s_sleep 1
    s_sub_u32 s55, s55, 1
    s_max_i32 s55, s55, 0
    s_cmp_lg_u32 s55, 0
    s_cbranch_scc1 Lw6
Lw6d:
    s_branch L_ld_e
L_gemm:
    s_mov_b32 s36, s8
    s_and_b32 s37, s9, 0xffff
    s_mov_b32 s38, 2097152
    s_mov_b32 s39, 0x00020000
    s_lshl_b32 s56, s3, 2
    v_add_u32 v13, s56, v15
    v_mov_b32 v14, 0x3f803f80
    v_and_b32 v10, 15, v0
    v_lshrrev_b32 v11, 4, v0
    v_lshrrev_b32 v18, 1, v10
    v_xor_b32 v18, v11, v18
    s_lshl_b32 s56, s60, 6
    v_add_u32 v19, s56, v10
    v_lshlrev_b32 v19, 7, v19
    v_lshl_add_u32 v2, v18, 4, v19
    v_xor_b32 v3, 64, v2
    v_and_b32 v18, 1, v11
    v_lshlrev_b32 v18, 5, v18
    v_lshl_add_u32 v18, v11, 9, v18
    v_bfe_u32 v19, v0, 2, 2
    v_lshl_add_u32 v18, v19, 6, v18
    v_and_b32 v19, 3, v0
    v_lshl_add_u32 v18, v19, 3, v18
    v_add_u32 v18, 16384, v18
    s_mul_i32 s56, s61, 3
    s_add_u32 s56, s56, 0
    s_and_b32 s57, s56, 1
    s_lshl_b32 s57, s57, 5
    s_lshr_b32 s56, s56, 1
    s_lshl_b32 s56, s56, 12
    v_xor_b32 v4, s57, v18
    v_add_u32 v4, s56, v4
    s_mul_i32 s56, s61, 3
    s_add_u32 s56, s56, 1
    s_and_b32 s57, s56, 1
    s_lshl_b32 s57, s57, 5
    s_lshr_b32 s56, s56, 1
    s_lshl_b32 s56, s56, 12
    v_xor_b32 v5, s57, v18
    v_add_u32 v5, s56, v5
    s_mul_i32 s56, s61, 3
    s_add_u32 s56, s56, 2
    s_and_b32 s57, s56, 1
    s_lshl_b32 s57, s57, 5
    s_lshr_b32 s56, s56, 1
    s_lshl_b32 s56, s56, 12
    v_xor_b32 v6, s57, v18
    v_add_u32 v6, s56, v6
    s_mov_b32 s62, 0
    s_mov_b32 s63, 0
    s_mov_b32 s64, 40960
    s_mov_b32 s65, 4294885376
    s_mov_b32 s49, 0
    s_lshl_b32 s56, s60, 8
    s_add_u32 s56, s56, 157952
    v_lshl_add_u32 v7, v10, 2, s56
    s_mul_i32 s56, s61, 384
    s_add_u32 s56, s56, 158464
    v_lshl_add_u32 v8, v11, 4, s56
    v_and_b32 v9, 1, v0
    v_lshl_add_u32 v9, v9, 2, v15
    s_mov_b32 s48, 1
    v_mov_b32 v32, 0
    v_mov_b32 v33, 0
    v_mov_b32 v34, 0
    v_mov_b32 v35, 0
    v_mov_b32 v36, 0
    v_mov_b32 v37, 0
    v_mov_b32 v38, 0
    v_mov_b32 v39, 0
    v_mov_b32 v40, 0
    v_mov_b32 v41, 0
    v_mov_b32 v42, 0
    v_mov_b32 v43, 0
    v_mov_b32 v44, 0
    v_mov_b32 v45, 0
    v_mov_b32 v46, 0
    v_mov_b32 v47, 0
    v_mov_b32 v48, 0
    v_mov_b32 v49, 0
    v_mov_b32 v50, 0
    v_mov_b32 v51, 0
    v_mov_b32 v52, 0
    v_mov_b32 v53, 0
    v_mov_b32 v54, 0
    v_mov_b32 v55, 0
    v_mov_b32 v56, 0
    v_mov_b32 v57, 0
    v_mov_b32 v58, 0
    v_mov_b32 v59, 0
    v_mov_b32 v60, 0
    v_mov_b32 v61, 0
    v_mov_b32 v62, 0
    v_mov_b32 v63, 0
    v_mov_b32 v64, 0
    v_mov_b32 v65, 0
    v_mov_b32 v66, 0
    v_mov_b32 v67, 0
    v_mov_b32 v68, 0
    v_mov_b32 v69, 0
    v_mov_b32 v70, 0
    v_mov_b32 v71, 0
    v_mov_b32 v72, 0
    v_mov_b32 v73, 0
    v_mov_b32 v74, 0
    v_mov_b32 v75, 0
    v_mov_b32 v76, 0
    v_mov_b32 v77, 0
    v_mov_b32 v78, 0
    v_mov_b32 v79, 0
    v_mov_b32 v80, 0
    v_mov_b32 v81, 0
    v_mov_b32 v82, 0
    v_mov_b32 v83, 0
    v_mov_b32 v84, 0
    v_mov_b32 v85, 0
    v_mov_b32 v86, 0
    v_mov_b32 v87, 0
    v_mov_b32 v88, 0
    v_mov_b32 v89, 0
    v_mov_b32 v90, 0
    v_mov_b32 v91, 0
    v_mov_b32 v92, 0
    v_mov_b32 v93, 0
    v_mov_b32 v94, 0
    v_mov_b32 v95, 0
    v_mov_b32 v96, 0
    v_mov_b32 v97, 0
    v_mov_b32 v98, 0
    v_mov_b32 v99, 0
    v_mov_b32 v100, 0
    v_mov_b32 v101, 0
    v_mov_b32 v102, 0
    v_mov_b32 v103, 0
    v_mov_b32 v104, 0
    v_mov_b32 v105, 0
    v_mov_b32 v106, 0
    v_mov_b32 v107, 0
    v_mov_b32 v108, 0
    v_mov_b32 v109, 0
    v_mov_b32 v110, 0
    v_mov_b32 v111, 0
    v_mov_b32 v112, 0
    v_mov_b32 v113, 0
    v_mov_b32 v114, 0
    v_mov_b32 v115, 0
    v_mov_b32 v116, 0
    v_mov_b32 v117, 0
    v_mov_b32 v118, 0
    v_mov_b32 v119, 0
    v_mov_b32 v120, 0
    v_mov_b32 v121, 0
    v_mov_b32 v122, 0
    v_mov_b32 v123, 0
    v_mov_b32 v124, 0
    v_mov_b32 v125, 0
    v_mov_b32 v126, 0
    v_mov_b32 v127, 0
    s_mul_i32 s58, s3, 8704
    s_add_u32 s58, s58, 122880
    v_lshl_add_u32 v16, v0, 2, s58
    v_and_b32 v17, 31, v0
    v_mul_u32_u24 v17, 272, v17
    v_lshrrev_b32 v18, 5, v0
    v_lshl_add_u32 v17, v18, 4, v17
    v_add_u32 v17, s58, v17
    v_lshl_add_u32 v18, v0, 4, s58
    s_mov_b32 s59, 1069066811
    s_mov_b32 s56, 0x3e22f983
    s_waitcnt vmcnt(3)
    v_and_b32 v20, 0xffff0000, v20
    v_and_b32 v21, 0xffff0000, v21
    v_mul_f32 v20, s59, v20
    v_mul_f32 v21, s59, v21
    v_exp_f32 v20, v20
    v_exp_f32 v21, v21
    s_nop 0
    v_cvt_pk_bf16_f32 v20, v20, v21
    v_and_b32 v21, 0xffff0000, v20
    v_lshlrev_b32 v20, 16, v20
    v_mul_f32 v20, v20, v21
    v_mul_f32 v20, s59, v20
    s_waitcnt vmcnt(2)
    v_and_b32 v22, 0xffff0000, v22
    v_mul_f32 v22, v22, v21
    v_mul_f32 v22, s56, v22
    v_mul_f32 v26, 0xc1000000, v20
    v_mul_f32 v29, 0x41000000, v22
    v_mul_f32 v27, 0xbf800000, v20
    v_mul_f32 v30, 0x3f800000, v22
    v_mul_f32 v28, 0xc3800000, v20
    v_mul_f32 v31, 0x43800000, v22
    v_exp_f32 v26, v26
    v_fract_f32 v29, v29
    v_exp_f32 v27, v27
    v_fract_f32 v30, v30
    v_exp_f32 v28, v28
    v_fract_f32 v31, v31
    v_cos_f32 v130, v29
    v_sin_f32 v131, v29
    v_cos_f32 v128, v30
    v_sin_f32 v129, v30
    v_cos_f32 v132, v31
    v_sin_f32 v133, v31
    v_mul_f32 v130, v130, v26
    v_mul_f32 v131, v131, v26
    v_mul_f32 v128, v128, v27
    v_mul_f32 v129, v129, v27
    v_mul_f32 v132, v132, v28
    v_mul_f32 v133, v133, v28
    s_waitcnt vmcnt(0)
    v_add_f32 v21, v21, v21
    v_and_b32 v24, 0xffff0000, v24
    v_and_b32 v25, 0xffff0000, v25
    v_mov_b32 v19, 0x3f80
    v_mul_f32 v160, v24, v21
    v_mul_f32 v161, v25, v21
    ds_write_b32 v16, v19
    v_pk_mul_f32 v[140:141], v[130:131], v[130:131] op_sel:[0,0] op_sel_hi:[0,1]
    v_pk_mul_f32 v[142:143], v[128:129], v[128:129] op_sel:[0,0] op_sel_hi:[0,1]
    v_pk_mul_f32 v[144:145], v[160:161], v[128:129] op_sel:[0,0] op_sel_hi:[0,1]
    v_pk_mul_f32 v[146:147], v[160:161], v[130:131] op_sel:[0,0] op_sel_hi:[0,1]
    v_pk_fma_f32 v[182:183], v[130:131], v[130:131], v[140:141] op_sel:[1,1,0] op_sel_hi:[1,0,1] neg_lo:[1,0,0]
    v_pk_fma_f32 v[134:135], v[128:129], v[128:129], v[142:143] op_sel:[1,1,0] op_sel_hi:[1,0,1] neg_lo:[1,0,0]
    v_pk_fma_f32 v[162:163], v[160:161], v[128:129], v[144:145] op_sel:[1,1,0] op_sel_hi:[1,0,1] neg_lo:[1,0,0]
    v_pk_fma_f32 v[176:177], v[160:161], v[130:131], v[146:147] op_sel:[1,1,0] op_sel_hi:[1,0,1] neg_lo:[1,0,0]
    v_pk_mul_f32 v[140:141], v[182:183], v[130:131] op_sel:[0,0] op_sel_hi:[0,1]
    v_pk_mul_f32 v[142:143], v[182:183], v[182:183] op_sel:[0,0] op_sel_hi:[0,1]
    v_pk_mul_f32 v[144:145], v[134:135], v[134:135] op_sel:[0,0] op_sel_hi:[0,1]
    v_pk_mul_f32 v[146:147], v[160:161], v[134:135] op_sel:[0,0] op_sel_hi:[0,1]
    v_pk_mul_f32 v[148:149], v[162:163], v[134:135] op_sel:[0,0] op_sel_hi:[0,1]
    v_pk_fma_f32 v[184:185], v[182:183], v[130:131], v[140:141] op_sel:[1,1,0] op_sel_hi:[1,0,1] neg_lo:[1,0,0]
    v_pk_fma_f32 v[138:139], v[182:183], v[182:183], v[142:143] op_sel:[1,1,0] op_sel_hi:[1,0,1] neg_lo:[1,0,0]
    v_pk_fma_f32 v[136:137], v[134:135], v[134:135], v[144:145] op_sel:[1,1,0] op_sel_hi:[1,0,1] neg_lo:[1,0,0]
    v_pk_fma_f32 v[164:165], v[160:161], v[134:135], v[146:147] op_sel:[1,1,0] op_sel_hi:[1,0,1] neg_lo:[1,0,0]
    v_pk_fma_f32 v[166:167], v[162:163], v[134:135], v[148:149] op_sel:[1,1,0] op_sel_hi:[1,0,1] neg_lo:[1,0,0]
    v_cvt_pk_bf16_f32 v152, v130, v131
    v_cvt_pk_bf16_f32 v153, v182, v183
    v_cvt_pk_bf16_f32 v154, v184, v185
    v_cvt_pk_bf16_f32 v155, v138, v139
    ds_write_b32 v16, v152 offset:272
    ds_write_b32 v16, v153 offset:544
    ds_write_b32 v16, v154 offset:816
    ds_write_b32 v16, v155 offset:1088
    v_pk_mul_f32 v[140:141], v[130:131], v[138:139] op_sel:[0,0] op_sel_hi:[0,1]
    v_pk_mul_f32 v[142:143], v[182:183], v[138:139] op_sel:[0,0] op_sel_hi:[0,1]
    v_pk_mul_f32 v[144:145], v[184:185], v[138:139] op_sel:[0,0] op_sel_hi:[0,1]
    v_pk_mul_f32 v[146:147], v[138:139], v[138:139] op_sel:[0,0] op_sel_hi:[0,1]
    v_pk_fma_f32 v[180:181], v[130:131], v[138:139], v[140:141] op_sel:[1,1,0] op_sel_hi:[1,0,1] neg_lo:[1,0,0]
    v_pk_fma_f32 v[182:183], v[182:183], v[138:139], v[142:143] op_sel:[1,1,0] op_sel_hi:[1,0,1] neg_lo:[1,0,0]
    v_pk_fma_f32 v[184:185], v[184:185], v[138:139], v[144:145] op_sel:[1,1,0] op_sel_hi:[1,0,1] neg_lo:[1,0,0]
    v_pk_fma_f32 v[186:187], v[138:139], v[138:139], v[146:147] op_sel:[1,1,0] op_sel_hi:[1,0,1] neg_lo:[1,0,0]
    v_cvt_pk_bf16_f32 v156, v180, v181
    v_cvt_pk_bf16_f32 v157, v182, v183
    v_cvt_pk_bf16_f32 v158, v184, v185
    v_cvt_pk_bf16_f32 v159, v186, v187
    ds_write_b32 v16, v156 offset:1360
    ds_write_b32 v16, v157 offset:1632
    ds_write_b32 v16, v158 offset:1904
    ds_write_b32 v16, v159 offset:2176
    v_pk_mul_f32 v[140:141], v[180:181], v[138:139] op_sel:[0,0] op_sel_hi:[0,1]
    v_pk_mul_f32 v[142:143], v[182:183], v[138:139] op_sel:[0,0] op_sel_hi:[0,1]
    v_pk_mul_f32 v[144:145], v[184:185], v[138:139] op_sel:[0,0] op_sel_hi:[0,1]
    v_pk_mul_f32 v[146:147], v[186:187], v[138:139] op_sel:[0,0] op_sel_hi:[0,1]
    v_pk_fma_f32 v[180:181], v[180:181], v[138:139], v[140:141] op_sel:[1,1,0] op_sel_hi:[1,0,1] neg_lo:[1,0,0]
    v_pk_fma_f32 v[182:183], v[182:183], v[138:139], v[142:143] op_sel:[1,1,0] op_sel_hi:[1,0,1] neg_lo:[1,0,0]
    v_pk_fma_f32 v[184:185], v[184:185], v[138:139], v[144:145] op_sel:[1,1,0] op_sel_hi:[1,0,1] neg_lo:[1,0,0]
    v_pk_fma_f32 v[186:187], v[186:187], v[138:139], v[146:147] op_sel:[1,1,0] op_sel_hi:[1,0,1] neg_lo:[1,0,0]
    v_cvt_pk_bf16_f32 v152, v180, v181
    v_cvt_pk_bf16_f32 v153, v182, v183
    v_cvt_pk_bf16_f32 v154, v184, v185
    v_cvt_pk_bf16_f32 v155, v186, v187
    ds_write_b32 v16, v152 offset:2448
    ds_write_b32 v16, v153 offset:2720
    ds_write_b32 v16, v154 offset:2992
    ds_write_b32 v16, v155 offset:3264
    v_pk_mul_f32 v[140:141], v[180:181], v[138:139] op_sel:[0,0] op_sel_hi:[0,1]
    v_pk_mul_f32 v[142:143], v[182:183], v[138:139] op_sel:[0,0] op_sel_hi:[0,1]
    v_pk_mul_f32 v[144:145], v[184:185], v[138:139] op_sel:[0,0] op_sel_hi:[0,1]
    v_pk_mul_f32 v[146:147], v[186:187], v[138:139] op_sel:[0,0] op_sel_hi:[0,1]
    v_pk_fma_f32 v[180:181], v[180:181], v[138:139], v[140:141] op_sel:[1,1,0] op_sel_hi:[1,0,1] neg_lo:[1,0,0]
    v_pk_fma_f32 v[182:183], v[182:183], v[138:139], v[142:143] op_sel:[1,1,0] op_sel_hi:[1,0,1] neg_lo:[1,0,0]
    v_pk_fma_f32 v[184:185], v[184:185], v[138:139], v[144:145] op_sel:[1,1,0] op_sel_hi:[1,0,1] neg_lo:[1,0,0]
    v_pk_fma_f32 v[186:187], v[186:187], v[138:139], v[146:147] op_sel:[1,1,0] op_sel_hi:[1,0,1] neg_lo:[1,0,0]
    v_cvt_pk_bf16_f32 v156, v180, v181
    v_cvt_pk_bf16_f32 v157, v182, v183
    v_cvt_pk_bf16_f32 v158, v184, v185
    v_cvt_pk_bf16_f32 v159, v186, v187
    ds_write_b32 v16, v156 offset:3536
    ds_write_b32 v16, v157 offset:3808
    ds_write_b32 v16, v158 offset:4080
    ds_write_b32 v16, v159 offset:4352
    v_pk_mul_f32 v[140:141], v[180:181], v[138:139] op_sel:[0,0] op_sel_hi:[0,1]
    v_pk_mul_f32 v[142:143], v[182:183], v[138:139] op_sel:[0,0] op_sel_hi:[0,1]
    v_pk_mul_f32 v[144:145], v[184:185], v[138:139] op_sel:[0,0] op_sel_hi:[0,1]
    v_pk_mul_f32 v[146:147], v[186:187], v[138:139] op_sel:[0,0] op_sel_hi:[0,1]
    v_pk_fma_f32 v[180:181], v[180:181], v[138:139], v[140:141] op_sel:[1,1,0] op_sel_hi:[1,0,1] neg_lo:[1,0,0]
    v_pk_fma_f32 v[182:183], v[182:183], v[138:139], v[142:143] op_sel:[1,1,0] op_sel_hi:[1,0,1] neg_lo:[1,0,0]
    v_pk_fma_f32 v[184:185], v[184:185], v[138:139], v[144:145] op_sel:[1,1,0] op_sel_hi:[1,0,1] neg_lo:[1,0,0]
    v_pk_fma_f32 v[186:187], v[186:187], v[138:139], v[146:147] op_sel:[1,1,0] op_sel_hi:[1,0,1] neg_lo:[1,0,0]
    v_cvt_pk_bf16_f32 v152, v180, v181
    v_cvt_pk_bf16_f32 v153, v182, v183
    v_cvt_pk_bf16_f32 v154, v184, v185
    v_cvt_pk_bf16_f32 v155, v186, v187
    ds_write_b32 v16, v152 offset:4624
    ds_write_b32 v16, v153 offset:4896
    ds_write_b32 v16, v154 offset:5168
    ds_write_b32 v16, v155 offset:5440
    v_pk_mul_f32 v[140:141], v[180:181], v[138:139] op_sel:[0,0] op_sel_hi:[0,1]
    v_pk_mul_f32 v[142:143], v[182:183], v[138:139] op_sel:[0,0] op_sel_hi:[0,1]
    v_pk_mul_f32 v[144:145], v[184:185], v[138:139] op_sel:[0,0] op_sel_hi:[0,1]
    v_pk_mul_f32 v[146:147], v[186:187], v[138:139] op_sel:[0,0] op_sel_hi:[0,1]
    v_pk_fma_f32 v[180:181], v[180:181], v[138:139], v[140:141] op_sel:[1,1,0] op_sel_hi:[1,0,1] neg_lo:[1,0,0]
    v_pk_fma_f32 v[182:183], v[182:183], v[138:139], v[142:143] op_sel:[1,1,0] op_sel_hi:[1,0,1] neg_lo:[1,0,0]
    v_pk_fma_f32 v[184:185], v[184:185], v[138:139], v[144:145] op_sel:[1,1,0] op_sel_hi:[1,0,1] neg_lo:[1,0,0]
    v_pk_fma_f32 v[186:187], v[186:187], v[138:139], v[146:147] op_sel:[1,1,0] op_sel_hi:[1,0,1] neg_lo:[1,0,0]
    v_cvt_pk_bf16_f32 v156, v180, v181
    v_cvt_pk_bf16_f32 v157, v182, v183
    v_cvt_pk_bf16_f32 v158, v184, v185
    v_cvt_pk_bf16_f32 v159, v186, v187
    ds_write_b32 v16, v156 offset:5712
    ds_write_b32 v16, v157 offset:5984
    ds_write_b32 v16, v158 offset:6256
    ds_write_b32 v16, v159 offset:6528
    v_pk_mul_f32 v[140:141], v[180:181], v[138:139] op_sel:[0,0] op_sel_hi:[0,1]
    v_pk_mul_f32 v[142:143], v[182:183], v[138:139] op_sel:[0,0] op_sel_hi:[0,1]
    v_pk_mul_f32 v[144:145], v[184:185], v[138:139] op_sel:[0,0] op_sel_hi:[0,1]
    v_pk_mul_f32 v[146:147], v[186:187], v[138:139] op_sel:[0,0] op_sel_hi:[0,1]
    v_pk_fma_f32 v[180:181], v[180:181], v[138:139], v[140:141] op_sel:[1,1,0] op_sel_hi:[1,0,1] neg_lo:[1,0,0]
    v_pk_fma_f32 v[182:183], v[182:183], v[138:139], v[142:143] op_sel:[1,1,0] op_sel_hi:[1,0,1] neg_lo:[1,0,0]
    v_pk_fma_f32 v[184:185], v[184:185], v[138:139], v[144:145] op_sel:[1,1,0] op_sel_hi:[1,0,1] neg_lo:[1,0,0]
    v_pk_fma_f32 v[186:187], v[186:187], v[138:139], v[146:147] op_sel:[1,1,0] op_sel_hi:[1,0,1] neg_lo:[1,0,0]
    v_cvt_pk_bf16_f32 v152, v180, v181
    v_cvt_pk_bf16_f32 v153, v182, v183
    v_cvt_pk_bf16_f32 v154, v184, v185
    v_cvt_pk_bf16_f32 v155, v186, v187
    ds_write_b32 v16, v152 offset:6800
    ds_write_b32 v16, v153 offset:7072
    ds_write_b32 v16, v154 offset:7344
    ds_write_b32 v16, v155 offset:7616
    v_pk_mul_f32 v[140:141], v[180:181], v[138:139] op_sel:[0,0] op_sel_hi:[0,1]
    v_pk_mul_f32 v[142:143], v[182:183], v[138:139] op_sel:[0,0] op_sel_hi:[0,1]
    v_pk_mul_f32 v[144:145], v[184:185], v[138:139] op_sel:[0,0] op_sel_hi:[0,1]
    v_pk_fma_f32 v[180:181], v[180:181], v[138:139], v[140:141] op_sel:[1,1,0] op_sel_hi:[1,0,1] neg_lo:[1,0,0]
    v_pk_fma_f32 v[182:183], v[182:183], v[138:139], v[142:143] op_sel:[1,1,0] op_sel_hi:[1,0,1] neg_lo:[1,0,0]
    v_pk_fma_f32 v[184:185], v[184:185], v[138:139], v[144:145] op_sel:[1,1,0] op_sel_hi:[1,0,1] neg_lo:[1,0,0]
    v_cvt_pk_bf16_f32 v156, v180, v181
    v_cvt_pk_bf16_f32 v157, v182, v183
    v_cvt_pk_bf16_f32 v158, v184, v185
    ds_write_b32 v16, v156 offset:7888
    ds_write_b32 v16, v157 offset:8160
    ds_write_b32 v16, v158 offset:8432
    v_pk_mul_f32 v[140:141], v[160:161], v[136:137] op_sel:[0,0] op_sel_hi:[0,1]
    v_pk_mul_f32 v[142:143], v[162:163], v[136:137] op_sel:[0,0] op_sel_hi:[0,1]
    v_pk_mul_f32 v[144:145], v[164:165], v[136:137] op_sel:[0,0] op_sel_hi:[0,1]
    v_pk_mul_f32 v[146:147], v[166:167], v[136:137] op_sel:[0,0] op_sel_hi:[0,1]
    v_pk_fma_f32 v[168:169], v[160:161], v[136:137], v[140:141] op_sel:[1,1,0] op_sel_hi:[1,0,1] neg_lo:[1,0,0]
    v_pk_fma_f32 v[170:171], v[162:163], v[136:137], v[142:143] op_sel:[1,1,0] op_sel_hi:[1,0,1] neg_lo:[1,0,0]
    v_pk_fma_f32 v[172:173], v[164:165], v[136:137], v[144:145] op_sel:[1,1,0] op_sel_hi:[1,0,1] neg_lo:[1,0,0]
    v_pk_fma_f32 v[174:175], v[166:167], v[136:137], v[146:147] op_sel:[1,1,0] op_sel_hi:[1,0,1] neg_lo:[1,0,0]
    s_waitcnt lgkmcnt(0)
    ds_read_b128 v[192:195], v17 offset:0
    ds_read_b128 v[196:199], v17 offset:32
    ds_read_b128 v[200:203], v17 offset:64
    ds_read_b128 v[204:207], v17 offset:96
    ds_read_b128 v[208:211], v17 offset:128
    ds_read_b128 v[212:215], v17 offset:160
    ds_read_b128 v[216:219], v17 offset:192
    ds_read_b128 v[220:223], v17 offset:224
    v_cvt_pk_bf16_f32 v152, v160, -v161
    v_cvt_pk_bf16_f32 v153, v162, -v163
    v_cvt_pk_bf16_f32 v154, v164, -v165
    v_cvt_pk_bf16_f32 v155, v166, -v167
    v_cvt_pk_bf16_f32 v156, v168, -v169
    v_cvt_pk_bf16_f32 v157, v170, -v171
    v_cvt_pk_bf16_f32 v158, v172, -v173
    v_cvt_pk_bf16_f32 v159, v174, -v175
    v_cvt_pk_bf16_f32 v19, v176, -v177
    v_pk_mul_f32 v[140:141], v[160:161], v[132:133] op_sel:[0,0] op_sel_hi:[0,1]
    v_pk_mul_f32 v[142:143], v[164:165], v[132:133] op_sel:[0,0] op_sel_hi:[0,1]
    v_pk_mul_f32 v[144:145], v[168:169], v[132:133] op_sel:[0,0] op_sel_hi:[0,1]
    v_pk_mul_f32 v[146:147], v[172:173], v[132:133] op_sel:[0,0] op_sel_hi:[0,1]
    v_pk_mul_f32 v[148:149], v[176:177], v[132:133] op_sel:[0,0] op_sel_hi:[0,1]
    v_pk_fma_f32 v[160:161], v[160:161], v[132:133], v[140:141] op_sel:[1,1,0] op_sel_hi:[1,0,1] neg_lo:[1,0,0]
    v_pk_fma_f32 v[164:165], v[164:165], v[132:133], v[142:143] op_sel:[1,1,0] op_sel_hi:[1,0,1] neg_lo:[1,0,0]
    v_pk_fma_f32 v[168:169], v[168:169], v[132:133], v[144:145] op_sel:[1,1,0] op_sel_hi:[1,0,1] neg_lo:[1,0,0]
    v_pk_fma_f32 v[172:173], v[172:173], v[132:133], v[146:147] op_sel:[1,1,0] op_sel_hi:[1,0,1] neg_lo:[1,0,0]
    v_pk_fma_f32 v[176:177], v[176:177], v[132:133], v[148:149] op_sel:[1,1,0] op_sel_hi:[1,0,1] neg_lo:[1,0,0]
    s_waitcnt lgkmcnt(0)
    ds_write_b32 v16, v152 offset:0
    ds_write_b32 v16, v153 offset:272
    ds_write_b32 v16, v154 offset:544
    ds_write_b32 v16, v155 offset:816
    ds_write_b32 v16, v156 offset:2176
    ds_write_b32 v16, v157 offset:2448
    ds_write_b32 v16, v158 offset:2720
    ds_write_b32 v16, v159 offset:2992
    ds_write_b32 v16, v19 offset:4352
    v_pk_mul_f32 v[140:141], v[132:133], v[132:133] op_sel:[0,0] op_sel_hi:[0,1]
    v_pk_mul_f32 v[142:143], v[160:161], v[132:133] op_sel:[0,0] op_sel_hi:[0,1]
    v_pk_mul_f32 v[144:145], v[168:169], v[132:133] op_sel:[0,0] op_sel_hi:[0,1]
    v_pk_mul_f32 v[146:147], v[176:177], v[132:133] op_sel:[0,0] op_sel_hi:[0,1]
    v_pk_fma_f32 v[134:135], v[132:133], v[132:133], v[140:141] op_sel:[1,1,0] op_sel_hi:[1,0,1] neg_lo:[1,0,0]
    v_pk_fma_f32 v[180:181], v[160:161], v[132:133], v[142:143] op_sel:[1,1,0] op_sel_hi:[1,0,1] neg_lo:[1,0,0]
    v_pk_fma_f32 v[182:183], v[168:169], v[132:133], v[144:145] op_sel:[1,1,0] op_sel_hi:[1,0,1] neg_lo:[1,0,0]
    v_pk_fma_f32 v[184:185], v[176:177], v[132:133], v[146:147] op_sel:[1,1,0] op_sel_hi:[1,0,1] neg_lo:[1,0,0]
    v_cvt_pk_bf16_f32 v159, v160, -v161
    v_cvt_pk_bf16_f32 v152, v164, -v165
    v_cvt_pk_bf16_f32 v153, v168, -v169
    v_cvt_pk_bf16_f32 v154, v172, -v173
    v_cvt_pk_bf16_f32 v155, v176, -v177
    ds_write_b32 v16, v159 offset:1088
    ds_write_b32 v16, v159 offset:1360
    ds_write_b32 v16, v152 offset:1632
    ds_write_b32 v16, v153 offset:1904
    ds_write_b32 v16, v153 offset:3264
    ds_write_b32 v16, v153 offset:3536
    ds_write_b32 v16, v154 offset:3808
    ds_write_b32 v16, v155 offset:4080
    ds_write_b32 v16, v155 offset:5440
    v_pk_mul_f32 v[140:141], v[160:161], v[134:135] op_sel:[0,0] op_sel_hi:[0,1]
    v_pk_mul_f32 v[142:143], v[168:169], v[134:135] op_sel:[0,0] op_sel_hi:[0,1]
    v_pk_mul_f32 v[144:145], v[176:177], v[134:135] op_sel:[0,0] op_sel_hi:[0,1]
    v_pk_mul_f32 v[146:147], v[180:181], v[134:135] op_sel:[0,0] op_sel_hi:[0,1]
    v_pk_mul_f32 v[148:149], v[184:185], v[134:135] op_sel:[0,0] op_sel_hi:[0,1]
    v_pk_fma_f32 v[160:161], v[160:161], v[134:135], v[140:141] op_sel:[1,1,0] op_sel_hi:[1,0,1] neg_lo:[1,0,0]
    v_pk_fma_f32 v[168:169], v[168:169], v[134:135], v[142:143] op_sel:[1,1,0] op_sel_hi:[1,0,1] neg_lo:[1,0,0]
    v_pk_fma_f32 v[176:177], v[176:177], v[134:135], v[144:145] op_sel:[1,1,0] op_sel_hi:[1,0,1] neg_lo:[1,0,0]
    v_pk_fma_f32 v[162:163], v[180:181], v[134:135], v[146:147] op_sel:[1,1,0] op_sel_hi:[1,0,1] neg_lo:[1,0,0]
    v_pk_fma_f32 v[166:167], v[184:185], v[134:135], v[148:149] op_sel:[1,1,0] op_sel_hi:[1,0,1] neg_lo:[1,0,0]
    v_cvt_pk_bf16_f32 v156, v180, -v181
    v_cvt_pk_bf16_f32 v157, v182, -v183
    v_cvt_pk_bf16_f32 v158, v184, -v185
    ds_write_b32 v16, v156 offset:4624
    ds_write_b32 v16, v157 offset:4896
    ds_write_b32 v16, v158 offset:5168
    v_pk_mul_f32 v[140:141], v[160:161], v[134:135] op_sel:[0,0] op_sel_hi:[0,1]
    v_pk_mul_f32 v[142:143], v[176:177], v[134:135] op_sel:[0,0] op_sel_hi:[0,1]
    v_pk_mul_f32 v[144:145], v[162:163], v[134:135] op_sel:[0,0] op_sel_hi:[0,1]
    v_pk_mul_f32 v[146:147], v[166:167], v[134:135] op_sel:[0,0] op_sel_hi:[0,1]
    v_pk_fma_f32 v[180:181], v[160:161], v[134:135], v[140:141] op_sel:[1,1,0] op_sel_hi:[1,0,1] neg_lo:[1,0,0]
    v_pk_fma_f32 v[182:183], v[176:177], v[134:135], v[142:143] op_sel:[1,1,0] op_sel_hi:[1,0,1] neg_lo:[1,0,0]
    v_pk_fma_f32 v[184:185], v[162:163], v[134:135], v[144:145] op_sel:[1,1,0] op_sel_hi:[1,0,1] neg_lo:[1,0,0]
    v_pk_fma_f32 v[186:187], v[166:167], v[134:135], v[146:147] op_sel:[1,1,0] op_sel_hi:[1,0,1] neg_lo:[1,0,0]
    v_cvt_pk_bf16_f32 v159, v160, -v161
    v_cvt_pk_bf16_f32 v152, v168, -v169
    v_cvt_pk_bf16_f32 v153, v176, -v177
    v_cvt_pk_bf16_f32 v154, v162, -v163
    v_cvt_pk_bf16_f32 v155, v166, -v167
    ds_write_b32 v16, v159 offset:5712
    ds_write_b32 v16, v152 offset:5984
    ds_write_b32 v16, v153 offset:6256
    ds_write_b32 v16, v154 offset:6528
    ds_write_b32 v16, v155 offset:6800
    v_pk_mul_f32 v[140:141], v[180:181], v[134:135] op_sel:[0,0] op_sel_hi:[0,1]
    v_pk_mul_f32 v[142:143], v[182:183], v[134:135] op_sel:[0,0] op_sel_hi:[0,1]
    v_pk_fma_f32 v[160:161], v[180:181], v[134:135], v[140:141] op_sel:[1,1,0] op_sel_hi:[1,0,1] neg_lo:[1,0,0]
    v_pk_fma_f32 v[176:177], v[182:183], v[134:135], v[142:143] op_sel:[1,1,0] op_sel_hi:[1,0,1] neg_lo:[1,0,0]
    v_cvt_pk_bf16_f32 v156, v180, -v181
    v_cvt_pk_bf16_f32 v157, v182, -v183
    v_cvt_pk_bf16_f32 v158, v184, -v185
    v_cvt_pk_bf16_f32 v159, v186, -v187
    ds_write_b32 v16, v156 offset:7616
    ds_write_b32 v16, v157 offset:7888
    ds_write_b32 v16, v158 offset:7072
    ds_write_b32 v16, v159 offset:7344
    v_cvt_pk_bf16_f32 v152, v160, -v161
    v_cvt_pk_bf16_f32 v153, v176, -v177
    ds_write_b32 v16, v152 offset:8160
    ds_write_b32 v16, v153 offset:8432
    s_waitcnt lgkmcnt(0)
    ds_read_b128 v[224:227], v17 offset:0
    ds_read_b128 v[228:231], v17 offset:32
    ds_read_b128 v[232:235], v17 offset:64
    ds_read_b128 v[236:239], v17 offset:96
    ds_read_b128 v[240:243], v17 offset:128
    ds_read_b128 v[244:247], v17 offset:160
    ds_read_b128 v[248:251], v17 offset:192
    ds_read_b128 v[252:255], v17 offset:224
    s_waitcnt lgkmcnt(7)
    v_mfma_f32_32x32x16_bf16 v[128:143], v[224:227], v[192:195], 0
    s_waitcnt lgkmcnt(6)
    v_mfma_f32_32x32x16_bf16 v[128:143], v[228:231], v[196:199], v[128:143]
    s_waitcnt lgkmcnt(5)
    v_mfma_f32_32x32x16_bf16 v[128:143], v[232:235], v[200:203], v[128:143]
    s_waitcnt lgkmcnt(4)
    v_mfma_f32_32x32x16_bf16 v[128:143], v[236:239], v[204:207], v[128:143]
    s_waitcnt lgkmcnt(3)
    v_mfma_f32_32x32x16_bf16 v[128:143], v[240:243], v[208:211], v[128:143]
    s_waitcnt lgkmcnt(2)
    v_mfma_f32_32x32x16_bf16 v[128:143], v[244:247], v[212:215], v[128:143]
    s_waitcnt lgkmcnt(1)
    v_mfma_f32_32x32x16_bf16 v[128:143], v[248:251], v[216:219], v[128:143]
    s_waitcnt lgkmcnt(0)
    v_mfma_f32_32x32x16_bf16 v[128:143], v[252:255], v[220:223], v[128:143]
    s_nop 11
    ds_write_b128 v18, v[128:131] offset:0
    ds_write_b128 v18, v[132:135] offset:1024
    ds_write_b128 v18, v[136:139] offset:2048
    ds_write_b128 v18, v[140:143] offset:3072
    v_mov_b32 v12, 1
    s_waitcnt lgkmcnt(0)
    ds_write_b32 v13, v12 offset:144
    s_lshr_b32 s57, s5, 2
    s_xor_b32 s57, s57, 4
    s_lshl_b32 s51, s33, 2
    s_add_u32 s51, s51, s3
    s_lshl_b32 s51, s51, 14
    s_lshl_b32 s58, s57, 7
    s_add_u32 s51, s51, s58
    v_lshlrev_b32 v31, 10, v10
    v_lshl_add_u32 v31, v11, 4, v31
    buffer_load_dwordx4 v[248:251], v31, s[36:39], s51 offen
    buffer_load_dwordx4 v[252:255], v31, s[36:39], s51 offen offset:64
    v_lshrrev_b32 v23, 3, v0
    v_cmp_lt_u32 vcc, 2, v23
    v_subrev_u32 v22, 3, v23
    s_nop 0
    v_cndmask_b32 v22, v23, v22, vcc
    v_mov_b32 v23, 88064
    v_cndmask_b32 v23, 0, v23, vcc
    v_lshl_add_u32 v23, v22, 10, v23
    v_and_b32 v24, 7, v0
    v_lshl_add_u32 v23, v24, 7, v23
    s_mul_i32 s56, s7, 6
    s_mul_i32 s57, s61, 3
    s_add_u32 s56, s56, s57
    s_sub_u32 s56, 86, s56
    s_min_i32 s56, s56, 3
    v_cmp_gt_i32 vcc, s56, v22
    s_nop 1
    v_cndmask_b32 v23, 2.0, v23, vcc
    s_mov_b32 s50, 0
    s_cmp_eq_u32 s32, 1
    s_cbranch_scc1 L_cs
Lv7:
    ds_read_b32 v16, v9 offset:0
    s_waitcnt lgkmcnt(0)
    v_cmp_gt_u32 vcc, s48, v16
    s_nop 0
    s_cbranch_vccz Lv7d
    s_sub_u32 s55, s55, 1
    s_max_i32 s55, s55, 0
    s_cmp_lg_u32 s55, 0
    s_cbranch_scc1 Lv7
Lv7d:
    ds_read_b64_tr_b16 v[144:145], v4 offset:0
    ds_read_b64_tr_b16 v[146:147], v4 offset:256
    ds_read_b128 v[128:131], v2 offset:0
    ds_read_b128 v[132:135], v2 offset:2048
    ds_read_b128 v[136:139], v2 offset:4096
    ds_read_b128 v[140:143], v2 offset:6144
    ds_read_b64_tr_b16 v[148:149], v4 offset:12288
    ds_read_b64_tr_b16 v[150:151], v4 offset:12544
    ds_read_b64_tr_b16 v[152:153], v5 offset:0
    ds_read_b64_tr_b16 v[154:155], v5 offset:256
    ds_read_b64_tr_b16 v[156:157], v5 offset:12288
    ds_read_b64_tr_b16 v[158:159], v5 offset:12544
    ds_read_b64_tr_b16 v[160:161], v6 offset:0
    ds_read_b64_tr_b16 v[162:163], v6 offset:256
    ds_read_b64_tr_b16 v[164:165], v6 offset:12288
    ds_read_b64_tr_b16 v[166:167], v6 offset:12544
.p2align 3
L_g1_loop:
    s_waitcnt lgkmcnt(0)
    v_mfma_f32_16x16x32_bf16 v[32:35], v[144:147], v[128:131], v[32:35]
    ds_read_b64_tr_b16 v[184:185], v4 offset:2048
    s_add_u32 s62, s62, 1
    v_mfma_f32_16x16x32_bf16 v[36:39], v[144:147], v[132:135], v[36:39]
    ds_read_b64_tr_b16 v[186:187], v4 offset:2304
    s_add_u32 s63, s63, 40960
    v_mfma_f32_16x16x32_bf16 v[40:43], v[144:147], v[136:139], v[40:43]
    ds_read_b128 v[168:171], v3 offset:0
    s_cmp_eq_u32 s63, 122880
    v_mfma_f32_16x16x32_bf16 v[44:47], v[144:147], v[140:143], v[44:47]
    ds_read_b128 v[172:175], v3 offset:2048
    s_cselect_b32 s57, s65, s64
    v_mfma_f32_16x16x32_bf16 v[60:63], v[148:151], v[140:143], v[60:63]
    ds_read_b128 v[176:179], v3 offset:4096
    s_cselect_b32 s63, 0, s63
    v_mfma_f32_16x16x32_bf16 v[56:59], v[148:151], v[136:139], v[56:59]
    ds_read_b128 v[180:183], v3 offset:6144
    s_add_u32 s48, s62, 1
    v_mfma_f32_16x16x32_bf16 v[52:55], v[148:151], v[132:135], v[52:55]
    ds_read_b64_tr_b16 v[188:189], v4 offset:14336
    v_add_u32 v2, s57, v2
    v_mfma_f32_16x16x32_bf16 v[48:51], v[148:151], v[128:131], v[48:51]
    ds_read_b64_tr_b16 v[190:191], v4 offset:14592
    v_add_u32 v3, s57, v3
    v_mfma_f32_16x16x32_bf16 v[64:67], v[152:155], v[128:131], v[64:67]
    ds_read_b64_tr_b16 v[192:193], v5 offset:2048
    v_add_u32 v4, s57, v4
    v_mfma_f32_16x16x32_bf16 v[68:71], v[152:155], v[132:135], v[68:71]
    ds_read_b64_tr_b16 v[194:195], v5 offset:2304
    v_mfma_f32_16x16x32_bf16 v[72:75], v[152:155], v[136:139], v[72:75]
    ds_read_b64_tr_b16 v[196:197], v5 offset:14336
    v_mfma_f32_16x16x32_bf16 v[76:79], v[152:155], v[140:143], v[76:79]
    ds_read_b64_tr_b16 v[198:199], v5 offset:14592
    v_mfma_f32_16x16x32_bf16 v[92:95], v[156:159], v[140:143], v[92:95]
    ds_read_b64_tr_b16 v[200:201], v6 offset:2048
    v_add_u32 v5, s57, v5
    v_mfma_f32_16x16x32_bf16 v[88:91], v[156:159], v[136:139], v[88:91]
    ds_read_b64_tr_b16 v[202:203], v6 offset:2304
    v_mfma_f32_16x16x32_bf16 v[84:87], v[156:159], v[132:135], v[84:87]
    ds_read_b64_tr_b16 v[204:205], v6 offset:14336
    v_mfma_f32_16x16x32_bf16 v[80:83], v[156:159], v[128:131], v[80:83]
    ds_read_b64_tr_b16 v[206:207], v6 offset:14592
    v_mfma_f32_16x16x32_bf16 v[96:99], v[160:163], v[128:131], v[96:99]
    v_add_u32 v6, s57, v6
    v_mfma_f32_16x16x32_bf16 v[100:103], v[160:163], v[132:135], v[100:103]
    ds_read_b32 v16, v9 offset:0
    v_mov_b32 v12, s62
    v_mfma_f32_16x16x32_bf16 v[104:107], v[160:163], v[136:139], v[104:107]
    v_mfma_f32_16x16x32_bf16 v[108:111], v[160:163], v[140:143], v[108:111]
    v_mfma_f32_16x16x32_bf16 v[124:127], v[164:167], v[140:143], v[124:127]
    v_mfma_f32_16x16x32_bf16 v[120:123], v[164:167], v[136:139], v[120:123]
    v_mfma_f32_16x16x32_bf16 v[116:119], v[164:167], v[132:135], v[116:119]
    s_waitcnt lgkmcnt(0)
    ds_write_b32 v13, v12 offset:16
    v_cmp_gt_u32 vcc, s48, v16
    v_mfma_f32_16x16x32_bf16 v[112:115], v[164:167], v[128:131], v[112:115]
    s_cmp_eq_u32 s62, 8
    s_cbranch_scc1 L_g1_end
    s_cbranch_vccnz L_g1_slow
    v_mfma_f32_16x16x32_bf16 v[32:35], v[184:187], v[168:171], v[32:35]
    ds_read_b64_tr_b16 v[144:145], v4 offset:0
    v_mfma_f32_16x16x32_bf16 v[36:39], v[184:187], v[172:175], v[36:39]
    ds_read_b64_tr_b16 v[146:147], v4 offset:256
    v_mfma_f32_16x16x32_bf16 v[40:43], v[184:187], v[176:179], v[40:43]
    ds_read_b128 v[128:131], v2 offset:0
    v_mfma_f32_16x16x32_bf16 v[44:47], v[184:187], v[180:183], v[44:47]
    ds_read_b128 v[132:135], v2 offset:2048
    v_mfma_f32_16x16x32_bf16 v[60:63], v[188:191], v[180:183], v[60:63]
    ds_read_b128 v[136:139], v2 offset:4096
    v_mfma_f32_16x16x32_bf16 v[56:59], v[188:191], v[176:179], v[56:59]
    ds_read_b128 v[140:143], v2 offset:6144
    v_mfma_f32_16x16x32_bf16 v[52:55], v[188:191], v[172:175], v[52:55]
    ds_read_b64_tr_b16 v[148:149], v4 offset:12288
    v_mfma_f32_16x16x32_bf16 v[48:51], v[188:191], v[168:171], v[48:51]
    ds_read_b64_tr_b16 v[150:151], v4 offset:12544
    v_mfma_f32_16x16x32_bf16 v[64:67], v[192:195], v[168:171], v[64:67]
    ds_read_b64_tr_b16 v[152:153], v5 offset:0
    v_mfma_f32_16x16x32_bf16 v[68:71], v[192:195], v[172:175], v[68:71]
    ds_read_b64_tr_b16 v[154:155], v5 offset:256
    v_mfma_f32_16x16x32_bf16 v[72:75], v[192:195], v[176:179], v[72:75]
    ds_read_b64_tr_b16 v[156:157], v5 offset:12288
    v_mfma_f32_16x16x32_bf16 v[76:79], v[192:195], v[180:183], v[76:79]
    ds_read_b64_tr_b16 v[158:159], v5 offset:12544
    v_mfma_f32_16x16x32_bf16 v[92:95], v[196:199], v[180:183], v[92:95]
    ds_read_b64_tr_b16 v[160:161], v6 offset:0
    v_mfma_f32_16x16x32_bf16 v[88:91], v[196:199], v[176:179], v[88:91]
    ds_read_b64_tr_b16 v[162:163], v6 offset:256
    v_mfma_f32_16x16x32_bf16 v[84:87], v[196:199], v[172:175], v[84:87]
    ds_read_b64_tr_b16 v[164:165], v6 offset:12288
    v_mfma_f32_16x16x32_bf16 v[80:83], v[196:199], v[168:171], v[80:83]
    ds_read_b64_tr_b16 v[166:167], v6 offset:12544
    v_mfma_f32_16x16x32_bf16 v[96:99], v[200:203], v[168:171], v[96:99]
    v_mfma_f32_16x16x32_bf16 v[100:103], v[200:203], v[172:175], v[100:103]
    v_mfma_f32_16x16x32_bf16 v[104:107], v[200:203], v[176:179], v[104:107]
    v_mfma_f32_16x16x32_bf16 v[108:111], v[200:203], v[180:183], v[108:111]
    v_mfma_f32_16x16x32_bf16 v[124:127], v[204:207], v[180:183], v[124:127]
    v_mfma_f32_16x16x32_bf16 v[120:123], v[204:207], v[176:179], v[120:123]
    v_mfma_f32_16x16x32_bf16 v[116:119], v[204:207], v[172:175], v[116:119]
    v_mfma_f32_16x16x32_bf16 v[112:115], v[204:207], v[168:171], v[112:115]
    s_branch L_g1_loop
L_g1_slow:
    v_mfma_f32_16x16x32_bf16 v[32:35], v[184:187], v[168:171], v[32:35]
    v_mfma_f32_16x16x32_bf16 v[36:39], v[184:187], v[172:175], v[36:39]
    v_mfma_f32_16x16x32_bf16 v[40:43], v[184:187], v[176:179], v[40:43]
    v_mfma_f32_16x16x32_bf16 v[44:47], v[184:187], v[180:183], v[44:47]
    v_mfma_f32_16x16x32_bf16 v[60:63], v[188:191], v[180:183], v[60:63]
    v_mfma_f32_16x16x32_bf16 v[56:59], v[188:191], v[176:179], v[56:59]
    ds_read_b32 v16, v9 offset:0
    v_mfma_f32_16x16x32_bf16 v[52:55], v[188:191], v[172:175], v[52:55]
    v_mfma_f32_16x16x32_bf16 v[48:51], v[188:191], v[168:171], v[48:51]
    v_mfma_f32_16x16x32_bf16 v[64:67], v[192:195], v[168:171], v[64:67]
    v_mfma_f32_16x16x32_bf16 v[68:71], v[192:195], v[172:175], v[68:71]
    s_waitcnt lgkmcnt(0)
    v_cmp_gt_u32 vcc, s48, v16
    s_nop 0
    s_cbranch_vccnz L_g1_slow2
    v_mfma_f32_16x16x32_bf16 v[72:75], v[192:195], v[176:179], v[72:75]
    ds_read_b64_tr_b16 v[144:145], v4 offset:0
    ds_read_b64_tr_b16 v[146:147], v4 offset:256
    v_mfma_f32_16x16x32_bf16 v[76:79], v[192:195], v[180:183], v[76:79]
    ds_read_b128 v[128:131], v2 offset:0
    ds_read_b128 v[132:135], v2 offset:2048
    v_mfma_f32_16x16x32_bf16 v[92:95], v[196:199], v[180:183], v[92:95]
    ds_read_b128 v[136:139], v2 offset:4096
    ds_read_b128 v[140:143], v2 offset:6144
    v_mfma_f32_16x16x32_bf16 v[88:91], v[196:199], v[176:179], v[88:91]
    ds_read_b64_tr_b16 v[148:149], v4 offset:12288
    ds_read_b64_tr_b16 v[150:151], v4 offset:12544
    v_mfma_f32_16x16x32_bf16 v[84:87], v[196:199], v[172:175], v[84:87]
    ds_read_b64_tr_b16 v[152:153], v5 offset:0
    v_mfma_f32_16x16x32_bf16 v[80:83], v[196:199], v[168:171], v[80:83]
    ds_read_b64_tr_b16 v[154:155], v5 offset:256
    v_mfma_f32_16x16x32_bf16 v[96:99], v[200:203], v[168:171], v[96:99]
    ds_read_b64_tr_b16 v[156:157], v5 offset:12288
    v_mfma_f32_16x16x32_bf16 v[100:103], v[200:203], v[172:175], v[100:103]
    ds_read_b64_tr_b16 v[158:159], v5 offset:12544
    v_mfma_f32_16x16x32_bf16 v[104:107], v[200:203], v[176:179], v[104:107]
    ds_read_b64_tr_b16 v[160:161], v6 offset:0
    v_mfma_f32_16x16x32_bf16 v[108:111], v[200:203], v[180:183], v[108:111]
    ds_read_b64_tr_b16 v[162:163], v6 offset:256
    v_mfma_f32_16x16x32_bf16 v[124:127], v[204:207], v[180:183], v[124:127]
    ds_read_b64_tr_b16 v[164:165], v6 offset:12288
    v_mfma_f32_16x16x32_bf16 v[120:123], v[204:207], v[176:179], v[120:123]
    ds_read_b64_tr_b16 v[166:167], v6 offset:12544
    v_mfma_f32_16x16x32_bf16 v[116:119], v[204:207], v[172:175], v[116:119]
    v_mfma_f32_16x16x32_bf16 v[112:115], v[204:207], v[168:171], v[112:115]
    s_branch L_g1_loop
L_g1_slow2:
    v_mfma_f32_16x16x32_bf16 v[72:75], v[192:195], v[176:179], v[72:75]
    v_mfma_f32_16x16x32_bf16 v[76:79], v[192:195], v[180:183], v[76:79]
    v_mfma_f32_16x16x32_bf16 v[92:95], v[196:199], v[180:183], v[92:95]
    v_mfma_f32_16x16x32_bf16 v[88:91], v[196:199], v[176:179], v[88:91]
    v_mfma_f32_16x16x32_bf16 v[84:87], v[196:199], v[172:175], v[84:87]
    v_mfma_f32_16x16x32_bf16 v[80:83], v[196:199], v[168:171], v[80:83]
    v_mfma_f32_16x16x32_bf16 v[96:99], v[200:203], v[168:171], v[96:99]
    v_mfma_f32_16x16x32_bf16 v[100:103], v[200:203], v[172:175], v[100:103]
    v_mfma_f32_16x16x32_bf16 v[104:107], v[200:203], v[176:179], v[104:107]
    ds_read_b32 v16, v9 offset:0
    v_mfma_f32_16x16x32_bf16 v[108:111], v[200:203], v[180:183], v[108:111]
    v_mfma_f32_16x16x32_bf16 v[124:127], v[204:207], v[180:183], v[124:127]
    v_mfma_f32_16x16x32_bf16 v[120:123], v[204:207], v[176:179], v[120:123]
    v_mfma_f32_16x16x32_bf16 v[116:119], v[204:207], v[172:175], v[116:119]
    v_mfma_f32_16x16x32_bf16 v[112:115], v[204:207], v[168:171], v[112:115]
Lv8:
    s_waitcnt lgkmcnt(0)
    v_cmp_gt_u32 vcc, s48, v16
    s_nop 0
    s_cbranch_vccz Lv8d
    ds_read_b32 v16, v9 offset:0
    s_sub_u32 s55, s55, 1
    s_max_i32 s55, s55, 0
    s_cmp_lg_u32 s55, 0
    s_cbranch_scc1 Lv8
Lv8d:
    ds_read_b64_tr_b16 v[144:145], v4 offset:0
    ds_read_b64_tr_b16 v[146:147], v4 offset:256
    ds_read_b128 v[128:131], v2 offset:0
    ds_read_b128 v[132:135], v2 offset:2048
    ds_read_b128 v[136:139], v2 offset:4096
    ds_read_b128 v[140:143], v2 offset:6144
    ds_read_b64_tr_b16 v[148:149], v4 offset:12288
    ds_read_b64_tr_b16 v[150:151], v4 offset:12544
    ds_read_b64_tr_b16 v[152:153], v5 offset:0
    ds_read_b64_tr_b16 v[154:155], v5 offset:256
    ds_read_b64_tr_b16 v[156:157], v5 offset:12288
    ds_read_b64_tr_b16 v[158:159], v5 offset:12544
    ds_read_b64_tr_b16 v[160:161], v6 offset:0
    ds_read_b64_tr_b16 v[162:163], v6 offset:256
    ds_read_b64_tr_b16 v[164:165], v6 offset:12288
    ds_read_b64_tr_b16 v[166:167], v6 offset:12544
    s_branch L_g1_loop
L_cs:
    s_cmp_eq_u32 s60, 0
    s_cbranch_scc1 L_cs_go
    v_mov_b32 v12, 8
    ds_write_b32 v13, v12 offset:16
    s_branch L_conv
L_cs_go:
    v_mov_b32 v128, v14
    v_mov_b32 v129, v14
    v_mov_b32 v130, v14
    v_mov_b32 v131, v14
L_cs_loop:
Lw9:
    ds_read_b64 v[16:17], v15 offset:0
    s_waitcnt lgkmcnt(0)
    v_min_u32 v16, v16, v17
    s_nop 0
    v_readfirstlane_b32 s67, v16
    s_nop 0
    s_cmp_gt_u32 s67, s62
    s_cbranch_scc1 Lw9d
    s_sub_u32 s55, s55, 1
    s_max_i32 s55, s55, 0
    s_cmp_lg_u32 s55, 0
    s_cbranch_scc1 Lw9
Lw9d:
    ds_read_b64_tr_b16 v[144:145], v4 offset:0
    ds_read_b64_tr_b16 v[146:147], v4 offset:256
    ds_read_b64_tr_b16 v[148:149], v4 offset:12288
    ds_read_b64_tr_b16 v[150:151], v4 offset:12544
    ds_read_b64_tr_b16 v[152:153], v5 offset:0
    ds_read_b64_tr_b16 v[154:155], v5 offset:256
    ds_read_b64_tr_b16 v[156:157], v5 offset:12288
    ds_read_b64_tr_b16 v[158:159], v5 offset:12544
    ds_read_b64_tr_b16 v[160:161], v6 offset:0
    ds_read_b64_tr_b16 v[162:163], v6 offset:256
    ds_read_b64_tr_b16 v[164:165], v6 offset:12288
    ds_read_b64_tr_b16 v[166:167], v6 offset:12544
    ds_read_b64_tr_b16 v[184:185], v4 offset:2048
    ds_read_b64_tr_b16 v[186:187], v4 offset:2304
    ds_read_b64_tr_b16 v[188:189], v4 offset:14336
    ds_read_b64_tr_b16 v[190:191], v4 offset:14592
    ds_read_b64_tr_b16 v[192:193], v5 offset:2048
    ds_read_b64_tr_b16 v[194:195], v5 offset:2304
    ds_read_b64_tr_b16 v[196:197], v5 offset:14336
    ds_read_b64_tr_b16 v[198:199], v5 offset:14592
    ds_read_b64_tr_b16 v[200:201], v6 offset:2048
    ds_read_b64_tr_b16 v[202:203], v6 offset:2304
    ds_read_b64_tr_b16 v[204:205], v6 offset:14336
    ds_read_b64_tr_b16 v[206:207], v6 offset:14592
    s_add_u32 s62, s62, 1
    s_add_u32 s63, s63, 40960
    s_cmp_eq_u32 s63, 122880
    s_cselect_b32 s57, s65, s64
    s_cselect_b32 s63, 0, s63
    v_mov_b32 v12, s62
    v_add_u32 v4, s57, v4
    v_add_u32 v5, s57, v5
    v_add_u32 v6, s57, v6
    s_waitcnt lgkmcnt(0)
    ds_write_b32 v13, v12 offset:16
    v_mfma_f32_16x16x32_bf16 v[32:35], v[128:131], v[144:147], v[32:35]
    v_mfma_f32_16x16x32_bf16 v[36:39], v[128:131], v[148:151], v[36:39]
    v_mfma_f32_16x16x32_bf16 v[40:43], v[128:131], v[152:155], v[40:43]
    v_mfma_f32_16x16x32_bf16 v[44:47], v[128:131], v[156:159], v[44:47]
    v_mfma_f32_16x16x32_bf16 v[48:51], v[128:131], v[160:163], v[48:51]
    v_mfma_f32_16x16x32_bf16 v[52:55], v[128:131], v[164:167], v[52:55]
    v_mfma_f32_16x16x32_bf16 v[32:35], v[128:131], v[184:187], v[32:35]
    v_mfma_f32_16x16x32_bf16 v[36:39], v[128:131], v[188:191], v[36:39]
    v_mfma_f32_16x16x32_bf16 v[40:43], v[128:131], v[192:195], v[40:43]
    v_mfma_f32_16x16x32_bf16 v[44:47], v[128:131], v[196:199], v[44:47]
    v_mfma_f32_16x16x32_bf16 v[48:51], v[128:131], v[200:203], v[48:51]
    v_mfma_f32_16x16x32_bf16 v[52:55], v[128:131], v[204:207], v[52:55]
    s_cmp_lt_u32 s62, 8
    s_cbranch_scc1 L_cs_loop
Lw10:
    ds_read_b32 v16, v15 offset:32
    s_waitcnt lgkmcnt(0)
    v_readfirstlane_b32 s67, v16
    s_nop 0
    s_cmp_lg_u32 s67, 0
    s_cbranch_scc1 Lw10d
    s_sub_u32 s55, s55, 1
    s_max_i32 s55, s55, 0
    s_cmp_lg_u32 s55, 0
    s_cbranch_scc1 Lw10
Lw10d:
    s_mov_b32 s52, s67
    s_lshl_b32 s56, s4, 4
    s_add_u32 s56, s56, s7
    s_cmp_eq_u32 s56, 999
    s_cselect_b32 s56, 15, s7
    s_lshl_b32 s56, s56, 1
    s_add_u32 s56, s56, s61
    s_mul_i32 s56, s56, 768
    s_add_u32 s56, s56, 49152
    v_lshlrev_b32 v18, 3, v0
    s_mov_b64 exec, 0xffff
    v_mov_b32 v33, s52
    buffer_store_dwordx2 v[32:33], v18, s[40:43], s56 offen offset:0 sc1
    v_mov_b32 v37, s52
    buffer_store_dwordx2 v[36:37], v18, s[40:43], s56 offen offset:128 sc1
    v_mov_b32 v41, s52
    buffer_store_dwordx2 v[40:41], v18, s[40:43], s56 offen offset:256 sc1
    v_mov_b32 v45, s52
    buffer_store_dwordx2 v[44:45], v18, s[40:43], s56 offen offset:384 sc1
    v_mov_b32 v49, s52
    buffer_store_dwordx2 v[48:49], v18, s[40:43], s56 offen offset:512 sc1
    v_mov_b32 v53, s52
    buffer_store_dwordx2 v[52:53], v18, s[40:43], s56 offen offset:640 sc1
    s_mov_b64 exec, -1
    s_lshl_b32 s56, s61, 2
    v_add_u32 v18, s56, v15
    ds_write_b32 v18, v12 offset:136
    s_branch L_conv
L_g1_end:
    v_mfma_f32_16x16x32_bf16 v[32:35], v[184:187], v[168:171], v[32:35]
    ds_read_b32 v16, v9 offset:136
    s_lshl_b32 s56, s6, 1
    s_add_u32 s56, s56, s60
    v_mfma_f32_16x16x32_bf16 v[36:39], v[184:187], v[172:175], v[36:39]
    s_mul_i32 s57, s56, 176128
    s_mul_i32 s58, s7, 6
    v_mfma_f32_16x16x32_bf16 v[40:43], v[184:187], v[176:179], v[40:43]
    s_mul_i32 s59, s61, 3
    s_add_u32 s58, s58, s59
    v_mfma_f32_16x16x32_bf16 v[44:47], v[184:187], v[180:183], v[44:47]
    s_lshl_b32 s59, s58, 10
    s_add_u32 s57, s57, s59
    v_mfma_f32_16x16x32_bf16 v[60:63], v[188:191], v[180:183], v[60:63]
    s_add_u32 s57, s57, 6356992
    s_mov_b32 s50, 3216550459
    v_mfma_f32_16x16x32_bf16 v[56:59], v[188:191], v[176:179], v[56:59]
    v_lshlrev_b32 v2, 4, v0
    s_waitcnt lgkmcnt(0)
    v_cmp_eq_u32 vcc, 0, v16
    s_nop 0
    s_cbranch_vccnz L_g1_late
    v_mfma_f32_16x16x32_bf16 v[52:55], v[188:191], v[172:175], v[52:55]
    ds_read_b32 v235, v7 offset:0
    ds_read_b32 v239, v7 offset:64
    v_mfma_f32_16x16x32_bf16 v[48:51], v[188:191], v[168:171], v[48:51]
    ds_read_b32 v243, v7 offset:128
    ds_read_b32 v247, v7 offset:192
    v_mfma_f32_16x16x32_bf16 v[64:67], v[192:195], v[168:171], v[64:67]
    ds_read_b128 v[208:211], v8 offset:0
    ds_read_b128 v[212:215], v8 offset:64
    v_mfma_f32_16x16x32_bf16 v[68:71], v[192:195], v[172:175], v[68:71]
    ds_read_b128 v[216:219], v8 offset:128
    ds_read_b128 v[220:223], v8 offset:192
    v_mfma_f32_16x16x32_bf16 v[72:75], v[192:195], v[176:179], v[72:75]
    ds_read_b128 v[224:227], v8 offset:256
    ds_read_b128 v[228:231], v8 offset:320
    v_mfma_f32_16x16x32_bf16 v[76:79], v[192:195], v[180:183], v[76:79]
    v_mfma_f32_16x16x32_bf16 v[92:95], v[196:199], v[180:183], v[92:95]
    v_mfma_f32_16x16x32_bf16 v[88:91], v[196:199], v[176:179], v[88:91]
    v_mfma_f32_16x16x32_bf16 v[84:87], v[196:199], v[172:175], v[84:87]
    s_waitcnt lgkmcnt(6)
    v_lshlrev_b32 v233, 16, v235
    v_lshlrev_b32 v237, 16, v239
    v_mfma_f32_16x16x32_bf16 v[80:83], v[196:199], v[168:171], v[80:83]
    v_lshlrev_b32 v241, 16, v243
    v_lshlrev_b32 v245, 16, v247
    v_mfma_f32_16x16x32_bf16 v[96:99], v[200:203], v[168:171], v[96:99]
    v_rcp_f32 v232, v233
    v_rcp_f32 v236, v237
    v_mfma_f32_16x16x32_bf16 v[100:103], v[200:203], v[172:175], v[100:103]
    v_rcp_f32 v240, v241
    v_rcp_f32 v244, v245
    v_mfma_f32_16x16x32_bf16 v[104:107], v[200:203], v[176:179], v[104:107]
    v_and_b32 v234, 0xffff0000, v235
    v_and_b32 v238, 0xffff0000, v239
    v_mfma_f32_16x16x32_bf16 v[108:111], v[200:203], v[180:183], v[108:111]
    v_and_b32 v242, 0xffff0000, v243
    v_and_b32 v246, 0xffff0000, v247
    v_mfma_f32_16x16x32_bf16 v[124:127], v[204:207], v[180:183], v[124:127]
    v_mul_f32 v233, v233, v233
    v_mul_f32 v232, s50, v232
    v_mfma_f32_16x16x32_bf16 v[120:123], v[204:207], v[176:179], v[120:123]
    v_mul_f32 v237, v237, v237
    v_mul_f32 v236, s50, v236
    v_mfma_f32_16x16x32_bf16 v[116:119], v[204:207], v[172:175], v[116:119]
    v_mul_f32 v241, v241, v241
    v_mul_f32 v240, s50, v240
    v_mfma_f32_16x16x32_bf16 v[112:115], v[204:207], v[168:171], v[112:115]
    v_mul_f32 v245, v245, v245
    v_mul_f32 v244, s50, v244
    s_branch L_g1_epi
L_g1_late:
    v_mfma_f32_16x16x32_bf16 v[52:55], v[188:191], v[172:175], v[52:55]
    v_mfma_f32_16x16x32_bf16 v[48:51], v[188:191], v[168:171], v[48:51]
    v_mfma_f32_16x16x32_bf16 v[64:67], v[192:195], v[168:171], v[64:67]
    v_mfma_f32_16x16x32_bf16 v[68:71], v[192:195], v[172:175], v[68:71]
    v_mfma_f32_16x16x32_bf16 v[72:75], v[192:195], v[176:179], v[72:75]
    v_mfma_f32_16x16x32_bf16 v[76:79], v[192:195], v[180:183], v[76:79]
    v_mfma_f32_16x16x32_bf16 v[92:95], v[196:199], v[180:183], v[92:95]
    v_mfma_f32_16x16x32_bf16 v[88:91], v[196:199], v[176:179], v[88:91]
    v_mfma_f32_16x16x32_bf16 v[84:87], v[196:199], v[172:175], v[84:87]
    v_mfma_f32_16x16x32_bf16 v[80:83], v[196:199], v[168:171], v[80:83]
    v_mfma_f32_16x16x32_bf16 v[96:99], v[200:203], v[168:171], v[96:99]
    v_mfma_f32_16x16x32_bf16 v[100:103], v[200:203], v[172:175], v[100:103]
    v_mfma_f32_16x16x32_bf16 v[104:107], v[200:203], v[176:179], v[104:107]
    v_mfma_f32_16x16x32_bf16 v[108:111], v[200:203], v[180:183], v[108:111]
    v_mfma_f32_16x16x32_bf16 v[124:127], v[204:207], v[180:183], v[124:127]
    v_mfma_f32_16x16x32_bf16 v[120:123], v[204:207], v[176:179], v[120:123]
    v_mfma_f32_16x16x32_bf16 v[116:119], v[204:207], v[172:175], v[116:119]
    v_mfma_f32_16x16x32_bf16 v[112:115], v[204:207], v[168:171], v[112:115]
Lv11:
    ds_read_b32 v16, v9 offset:136
    s_waitcnt lgkmcnt(0)
    v_cmp_gt_u32 vcc, 1, v16
    s_nop 0
    s_cbranch_vccz Lv11d
    s_sub_u32 s55, s55, 1
    s_max_i32 s55, s55, 0
    s_cmp_lg_u32 s55, 0
    s_cbranch_scc1 Lv11
Lv11d:
    ds_read_b32 v235, v7 offset:0
    ds_read_b32 v239, v7 offset:64
    ds_read_b32 v243, v7 offset:128
    ds_read_b32 v247, v7 offset:192
    ds_read_b128 v[208:211], v8 offset:0
    ds_read_b128 v[212:215], v8 offset:64
    ds_read_b128 v[216:219], v8 offset:128
    ds_read_b128 v[220:223], v8 offset:192
    ds_read_b128 v[224:227], v8 offset:256
    ds_read_b128 v[228:231], v8 offset:320
    s_waitcnt lgkmcnt(6)
    v_lshlrev_b32 v233, 16, v235
    v_lshlrev_b32 v237, 16, v239
    v_lshlrev_b32 v241, 16, v243
    v_lshlrev_b32 v245, 16, v247
    v_rcp_f32 v232, v233
    v_rcp_f32 v236, v237
    v_rcp_f32 v240, v241
    v_rcp_f32 v244, v245
    v_and_b32 v234, 0xffff0000, v235
    v_and_b32 v238, 0xffff0000, v239
    v_and_b32 v242, 0xffff0000, v243
    v_and_b32 v246, 0xffff0000, v247
    v_mul_f32 v233, v233, v233
    v_mul_f32 v232, s50, v232
    v_mul_f32 v237, v237, v237
    v_mul_f32 v236, s50, v236
    v_mul_f32 v241, v241, v241
    v_mul_f32 v240, s50, v240
    v_mul_f32 v245, v245, v245
    v_mul_f32 v244, s50, v244
L_g1_epi:
    s_waitcnt lgkmcnt(0)
    v_pk_fma_f32 v[32:33], v[208:209], v[234:235], v[32:33] op_sel_hi:[1,0,1]
    v_pk_fma_f32 v[34:35], v[210:211], v[234:235], v[34:35] op_sel_hi:[1,0,1]
    v_pk_fma_f32 v[36:37], v[208:209], v[238:239], v[36:37] op_sel_hi:[1,0,1]
    v_pk_fma_f32 v[38:39], v[210:211], v[238:239], v[38:39] op_sel_hi:[1,0,1]
    v_pk_mul_f32 v[128:129], v[32:33], v[232:233] op_sel_hi:[1,0]
    v_pk_mul_f32 v[130:131], v[34:35], v[232:233] op_sel_hi:[1,0]
    v_pk_mul_f32 v[132:133], v[36:37], v[236:237] op_sel_hi:[1,0]
    v_pk_mul_f32 v[134:135], v[38:39], v[236:237] op_sel_hi:[1,0]
    v_pk_fma_f32 v[48:49], v[212:213], v[234:235], v[48:49] op_sel_hi:[1,0,1]
    v_pk_fma_f32 v[50:51], v[214:215], v[234:235], v[50:51] op_sel_hi:[1,0,1]
    v_pk_fma_f32 v[52:53], v[212:213], v[238:239], v[52:53] op_sel_hi:[1,0,1]
    v_pk_fma_f32 v[54:55], v[214:215], v[238:239], v[54:55] op_sel_hi:[1,0,1]
    v_exp_f32 v128, v128
    v_exp_f32 v129, v129
    v_exp_f32 v130, v130
    v_exp_f32 v131, v131
    v_exp_f32 v132, v132
    v_exp_f32 v133, v133
    v_exp_f32 v134, v134
    v_exp_f32 v135, v135
    v_pk_mul_f32 v[136:137], v[32:33], v[48:49]
    v_pk_mul_f32 v[138:139], v[34:35], v[50:51]
    v_pk_mul_f32 v[140:141], v[36:37], v[52:53]
    v_pk_mul_f32 v[142:143], v[38:39], v[54:55]
    v_pk_fma_f32 v[128:129], v[128:129], v[232:233], v[232:233] op_sel:[0,1,1] op_sel_hi:[1,1,1]
    v_pk_fma_f32 v[130:131], v[130:131], v[232:233], v[232:233] op_sel:[0,1,1] op_sel_hi:[1,1,1]
    v_pk_fma_f32 v[132:133], v[132:133], v[236:237], v[236:237] op_sel:[0,1,1] op_sel_hi:[1,1,1]
    v_pk_fma_f32 v[134:135], v[134:135], v[236:237], v[236:237] op_sel:[0,1,1] op_sel_hi:[1,1,1]
    v_rcp_f32 v128, v128
    v_rcp_f32 v129, v129
    v_rcp_f32 v130, v130
    v_rcp_f32 v131, v131
    v_rcp_f32 v132, v132
    v_rcp_f32 v133, v133
    v_rcp_f32 v134, v134
    v_rcp_f32 v135, v135
    v_pk_mul_f32 v[136:137], v[136:137], v[128:129]
    v_pk_mul_f32 v[138:139], v[138:139], v[130:131]
    v_pk_mul_f32 v[140:141], v[140:141], v[132:133]
    v_pk_mul_f32 v[142:143], v[142:143], v[134:135]
    v_cvt_pk_bf16_f32 v192, v136, v137
    v_cvt_pk_bf16_f32 v193, v138, v139
    v_cvt_pk_bf16_f32 v194, v140, v141
    v_cvt_pk_bf16_f32 v195, v142, v143
    s_add_u32 s59, s58, 0
    s_cmp_ge_u32 s59, 86
    v_permlane16_swap_b32 v192, v194
    v_permlane16_swap_b32 v193, v195
    s_cbranch_scc1 Lhs12
    s_add_u32 s59, s57, 0
    buffer_store_dwordx4 v[192:195], v2, s[40:43], s59 offen sc1
Lhs12:
    v_pk_fma_f32 v[40:41], v[208:209], v[242:243], v[40:41] op_sel_hi:[1,0,1]
    v_pk_fma_f32 v[42:43], v[210:211], v[242:243], v[42:43] op_sel_hi:[1,0,1]
    v_pk_fma_f32 v[44:45], v[208:209], v[246:247], v[44:45] op_sel_hi:[1,0,1]
    v_pk_fma_f32 v[46:47], v[210:211], v[246:247], v[46:47] op_sel_hi:[1,0,1]
    v_pk_mul_f32 v[128:129], v[40:41], v[240:241] op_sel_hi:[1,0]
    v_pk_mul_f32 v[130:131], v[42:43], v[240:241] op_sel_hi:[1,0]
    v_pk_mul_f32 v[132:133], v[44:45], v[244:245] op_sel_hi:[1,0]
    v_pk_mul_f32 v[134:135], v[46:47], v[244:245] op_sel_hi:[1,0]
    v_pk_fma_f32 v[56:57], v[212:213], v[242:243], v[56:57] op_sel_hi:[1,0,1]
    v_pk_fma_f32 v[58:59], v[214:215], v[242:243], v[58:59] op_sel_hi:[1,0,1]
    v_pk_fma_f32 v[60:61], v[212:213], v[246:247], v[60:61] op_sel_hi:[1,0,1]
    v_pk_fma_f32 v[62:63], v[214:215], v[246:247], v[62:63] op_sel_hi:[1,0,1]
    v_exp_f32 v128, v128
    v_exp_f32 v129, v129
    v_exp_f32 v130, v130
    v_exp_f32 v131, v131
    v_exp_f32 v132, v132
    v_exp_f32 v133, v133
    v_exp_f32 v134, v134
    v_exp_f32 v135, v135
    v_pk_mul_f32 v[136:137], v[40:41], v[56:57]
    v_pk_mul_f32 v[138:139], v[42:43], v[58:59]
    v_pk_mul_f32 v[140:141], v[44:45], v[60:61]
    v_pk_mul_f32 v[142:143], v[46:47], v[62:63]
    v_pk_fma_f32 v[128:129], v[128:129], v[240:241], v[240:241] op_sel:[0,1,1] op_sel_hi:[1,1,1]
    v_pk_fma_f32 v[130:131], v[130:131], v[240:241], v[240:241] op_sel:[0,1,1] op_sel_hi:[1,1,1]
    v_pk_fma_f32 v[132:133], v[132:133], v[244:245], v[244:245] op_sel:[0,1,1] op_sel_hi:[1,1,1]
    v_pk_fma_f32 v[134:135], v[134:135], v[244:245], v[244:245] op_sel:[0,1,1] op_sel_hi:[1,1,1]
    v_rcp_f32 v128, v128
    v_rcp_f32 v129, v129
    v_rcp_f32 v130, v130
    v_rcp_f32 v131, v131
    v_rcp_f32 v132, v132
    v_rcp_f32 v133, v133
    v_rcp_f32 v134, v134
    v_rcp_f32 v135, v135
    v_pk_mul_f32 v[136:137], v[136:137], v[128:129]
    v_pk_mul_f32 v[138:139], v[138:139], v[130:131]
    v_pk_mul_f32 v[140:141], v[140:141], v[132:133]
    v_pk_mul_f32 v[142:143], v[142:143], v[134:135]
    v_cvt_pk_bf16_f32 v196, v136, v137
    v_cvt_pk_bf16_f32 v197, v138, v139
    v_cvt_pk_bf16_f32 v198, v140, v141
    v_cvt_pk_bf16_f32 v199, v142, v143
    s_add_u32 s59, s58, 0
    s_cmp_ge_u32 s59, 86
    v_permlane16_swap_b32 v196, v198
    v_permlane16_swap_b32 v197, v199
    s_cbranch_scc1 Lhs13
    s_add_u32 s59, s57, 88064
    buffer_store_dwordx4 v[196:199], v2, s[40:43], s59 offen sc1
Lhs13:
    v_pk_fma_f32 v[64:65], v[216:217], v[234:235], v[64:65] op_sel_hi:[1,0,1]
    v_pk_fma_f32 v[66:67], v[218:219], v[234:235], v[66:67] op_sel_hi:[1,0,1]
    v_pk_fma_f32 v[68:69], v[216:217], v[238:239], v[68:69] op_sel_hi:[1,0,1]
    v_pk_fma_f32 v[70:71], v[218:219], v[238:239], v[70:71] op_sel_hi:[1,0,1]
    v_pk_mul_f32 v[128:129], v[64:65], v[232:233] op_sel_hi:[1,0]
    v_pk_mul_f32 v[130:131], v[66:67], v[232:233] op_sel_hi:[1,0]
    v_pk_mul_f32 v[132:133], v[68:69], v[236:237] op_sel_hi:[1,0]
    v_pk_mul_f32 v[134:135], v[70:71], v[236:237] op_sel_hi:[1,0]
    v_pk_fma_f32 v[80:81], v[220:221], v[234:235], v[80:81] op_sel_hi:[1,0,1]
    v_pk_fma_f32 v[82:83], v[222:223], v[234:235], v[82:83] op_sel_hi:[1,0,1]
    v_pk_fma_f32 v[84:85], v[220:221], v[238:239], v[84:85] op_sel_hi:[1,0,1]
    v_pk_fma_f32 v[86:87], v[222:223], v[238:239], v[86:87] op_sel_hi:[1,0,1]
    v_exp_f32 v128, v128
    v_exp_f32 v129, v129
    v_exp_f32 v130, v130
    v_exp_f32 v131, v131
    v_exp_f32 v132, v132
    v_exp_f32 v133, v133
    v_exp_f32 v134, v134
    v_exp_f32 v135, v135
    v_pk_mul_f32 v[136:137], v[64:65], v[80:81]
    v_pk_mul_f32 v[138:139], v[66:67], v[82:83]
    v_pk_mul_f32 v[140:141], v[68:69], v[84:85]
    v_pk_mul_f32 v[142:143], v[70:71], v[86:87]
    v_pk_fma_f32 v[128:129], v[128:129], v[232:233], v[232:233] op_sel:[0,1,1] op_sel_hi:[1,1,1]
    v_pk_fma_f32 v[130:131], v[130:131], v[232:233], v[232:233] op_sel:[0,1,1] op_sel_hi:[1,1,1]
    v_pk_fma_f32 v[132:133], v[132:133], v[236:237], v[236:237] op_sel:[0,1,1] op_sel_hi:[1,1,1]
    v_pk_fma_f32 v[134:135], v[134:135], v[236:237], v[236:237] op_sel:[0,1,1] op_sel_hi:[1,1,1]
    v_rcp_f32 v128, v128
    v_rcp_f32 v129, v129
    v_rcp_f32 v130, v130
    v_rcp_f32 v131, v131
    v_rcp_f32 v132, v132
    v_rcp_f32 v133, v133
    v_rcp_f32 v134, v134
    v_rcp_f32 v135, v135
    v_pk_mul_f32 v[136:137], v[136:137], v[128:129]
    v_pk_mul_f32 v[138:139], v[138:139], v[130:131]
    v_pk_mul_f32 v[140:141], v[140:141], v[132:133]
    v_pk_mul_f32 v[142:143], v[142:143], v[134:135]
    v_cvt_pk_bf16_f32 v200, v136, v137
    v_cvt_pk_bf16_f32 v201, v138, v139
    v_cvt_pk_bf16_f32 v202, v140, v141
    v_cvt_pk_bf16_f32 v203, v142, v143
    s_add_u32 s59, s58, 1
    s_cmp_ge_u32 s59, 86
    v_permlane16_swap_b32 v200, v202
    v_permlane16_swap_b32 v201, v203
    s_cbranch_scc1 Lhs14
    s_add_u32 s59, s57, 1024
    buffer_store_dwordx4 v[200:203], v2, s[40:43], s59 offen sc1
Lhs14:
    v_pk_fma_f32 v[72:73], v[216:217], v[242:243], v[72:73] op_sel_hi:[1,0,1]
    v_pk_fma_f32 v[74:75], v[218:219], v[242:243], v[74:75] op_sel_hi:[1,0,1]
    v_pk_fma_f32 v[76:77], v[216:217], v[246:247], v[76:77] op_sel_hi:[1,0,1]
    v_pk_fma_f32 v[78:79], v[218:219], v[246:247], v[78:79] op_sel_hi:[1,0,1]
    v_pk_mul_f32 v[128:129], v[72:73], v[240:241] op_sel_hi:[1,0]
    v_pk_mul_f32 v[130:131], v[74:75], v[240:241] op_sel_hi:[1,0]
    v_pk_mul_f32 v[132:133], v[76:77], v[244:245] op_sel_hi:[1,0]
    v_pk_mul_f32 v[134:135], v[78:79], v[244:245] op_sel_hi:[1,0]
    v_pk_fma_f32 v[88:89], v[220:221], v[242:243], v[88:89] op_sel_hi:[1,0,1]
    v_pk_fma_f32 v[90:91], v[222:223], v[242:243], v[90:91] op_sel_hi:[1,0,1]
    v_pk_fma_f32 v[92:93], v[220:221], v[246:247], v[92:93] op_sel_hi:[1,0,1]
    v_pk_fma_f32 v[94:95], v[222:223], v[246:247], v[94:95] op_sel_hi:[1,0,1]
    v_exp_f32 v128, v128
    v_exp_f32 v129, v129
    v_exp_f32 v130, v130
    v_exp_f32 v131, v131
    v_exp_f32 v132, v132
    v_exp_f32 v133, v133
    v_exp_f32 v134, v134
    v_exp_f32 v135, v135
    v_pk_mul_f32 v[136:137], v[72:73], v[88:89]
    v_pk_mul_f32 v[138:139], v[74:75], v[90:91]
    v_pk_mul_f32 v[140:141], v[76:77], v[92:93]
    v_pk_mul_f32 v[142:143], v[78:79], v[94:95]
    v_pk_fma_f32 v[128:129], v[128:129], v[240:241], v[240:241] op_sel:[0,1,1] op_sel_hi:[1,1,1]
    v_pk_fma_f32 v[130:131], v[130:131], v[240:241], v[240:241] op_sel:[0,1,1] op_sel_hi:[1,1,1]
    v_pk_fma_f32 v[132:133], v[132:133], v[244:245], v[244:245] op_sel:[0,1,1] op_sel_hi:[1,1,1]
    v_pk_fma_f32 v[134:135], v[134:135], v[244:245], v[244:245] op_sel:[0,1,1] op_sel_hi:[1,1,1]
    v_rcp_f32 v128, v128
    v_rcp_f32 v129, v129
    v_rcp_f32 v130, v130
    v_rcp_f32 v131, v131
    v_rcp_f32 v132, v132
    v_rcp_f32 v133, v133
    v_rcp_f32 v134, v134
    v_rcp_f32 v135, v135
    v_pk_mul_f32 v[136:137], v[136:137], v[128:129]
    v_pk_mul_f32 v[138:139], v[138:139], v[130:131]
    v_pk_mul_f32 v[140:141], v[140:141], v[132:133]
    v_pk_mul_f32 v[142:143], v[142:143], v[134:135]
    v_cvt_pk_bf16_f32 v192, v136, v137
    v_cvt_pk_bf16_f32 v193, v138, v139
    v_cvt_pk_bf16_f32 v194, v140, v141
    v_cvt_pk_bf16_f32 v195, v142, v143
    s_add_u32 s59, s58, 1
    s_cmp_ge_u32 s59, 86
    v_permlane16_swap_b32 v192, v194
    v_permlane16_swap_b32 v193, v195
    s_cbranch_scc1 Lhs15
    s_add_u32 s59, s57, 89088
    buffer_store_dwordx4 v[192:195], v2, s[40:43], s59 offen sc1
Lhs15:
    v_pk_fma_f32 v[96:97], v[224:225], v[234:235], v[96:97] op_sel_hi:[1,0,1]
    v_pk_fma_f32 v[98:99], v[226:227], v[234:235], v[98:99] op_sel_hi:[1,0,1]
    v_pk_fma_f32 v[100:101], v[224:225], v[238:239], v[100:101] op_sel_hi:[1,0,1]
    v_pk_fma_f32 v[102:103], v[226:227], v[238:239], v[102:103] op_sel_hi:[1,0,1]
    v_pk_mul_f32 v[128:129], v[96:97], v[232:233] op_sel_hi:[1,0]
    v_pk_mul_f32 v[130:131], v[98:99], v[232:233] op_sel_hi:[1,0]
    v_pk_mul_f32 v[132:133], v[100:101], v[236:237] op_sel_hi:[1,0]
    v_pk_mul_f32 v[134:135], v[102:103], v[236:237] op_sel_hi:[1,0]
    v_pk_fma_f32 v[112:113], v[228:229], v[234:235], v[112:113] op_sel_hi:[1,0,1]
    v_pk_fma_f32 v[114:115], v[230:231], v[234:235], v[114:115] op_sel_hi:[1,0,1]
    v_pk_fma_f32 v[116:117], v[228:229], v[238:239], v[116:117] op_sel_hi:[1,0,1]
    v_pk_fma_f32 v[118:119], v[230:231], v[238:239], v[118:119] op_sel_hi:[1,0,1]
    v_exp_f32 v128, v128
    v_exp_f32 v129, v129
    v_exp_f32 v130, v130
    v_exp_f32 v131, v131
    v_exp_f32 v132, v132
    v_exp_f32 v133, v133
    v_exp_f32 v134, v134
    v_exp_f32 v135, v135
    v_pk_mul_f32 v[136:137], v[96:97], v[112:113]
    v_pk_mul_f32 v[138:139], v[98:99], v[114:115]
    v_pk_mul_f32 v[140:141], v[100:101], v[116:117]
    v_pk_mul_f32 v[142:143], v[102:103], v[118:119]
    v_pk_fma_f32 v[128:129], v[128:129], v[232:233], v[232:233] op_sel:[0,1,1] op_sel_hi:[1,1,1]
    v_pk_fma_f32 v[130:131], v[130:131], v[232:233], v[232:233] op_sel:[0,1,1] op_sel_hi:[1,1,1]
    v_pk_fma_f32 v[132:133], v[132:133], v[236:237], v[236:237] op_sel:[0,1,1] op_sel_hi:[1,1,1]
    v_pk_fma_f32 v[134:135], v[134:135], v[236:237], v[236:237] op_sel:[0,1,1] op_sel_hi:[1,1,1]
    v_rcp_f32 v128, v128
    v_rcp_f32 v129, v129
    v_rcp_f32 v130, v130
    v_rcp_f32 v131, v131
    v_rcp_f32 v132, v132
    v_rcp_f32 v133, v133
    v_rcp_f32 v134, v134
    v_rcp_f32 v135, v135
    v_pk_mul_f32 v[136:137], v[136:137], v[128:129]
    v_pk_mul_f32 v[138:139], v[138:139], v[130:131]
    v_pk_mul_f32 v[140:141], v[140:141], v[132:133]
    v_pk_mul_f32 v[142:143], v[142:143], v[134:135]
    v_cvt_pk_bf16_f32 v196, v136, v137
    v_cvt_pk_bf16_f32 v197, v138, v139
    v_cvt_pk_bf16_f32 v198, v140, v141
    v_cvt_pk_bf16_f32 v199, v142, v143
    s_add_u32 s59, s58, 2
    s_cmp_ge_u32 s59, 86
    v_permlane16_swap_b32 v196, v198
    v_permlane16_swap_b32 v197, v199
    s_cbranch_scc1 Lhs16
    s_add_u32 s59, s57, 2048
    buffer_store_dwordx4 v[196:199], v2, s[40:43], s59 offen sc1
Lhs16:
    v_pk_fma_f32 v[104:105], v[224:225], v[242:243], v[104:105] op_sel_hi:[1,0,1]
    v_pk_fma_f32 v[106:107], v[226:227], v[242:243], v[106:107] op_sel_hi:[1,0,1]
    v_pk_fma_f32 v[108:109], v[224:225], v[246:247], v[108:109] op_sel_hi:[1,0,1]
    v_pk_fma_f32 v[110:111], v[226:227], v[246:247], v[110:111] op_sel_hi:[1,0,1]
    v_pk_mul_f32 v[128:129], v[104:105], v[240:241] op_sel_hi:[1,0]
    v_pk_mul_f32 v[130:131], v[106:107], v[240:241] op_sel_hi:[1,0]
    v_pk_mul_f32 v[132:133], v[108:109], v[244:245] op_sel_hi:[1,0]
    v_pk_mul_f32 v[134:135], v[110:111], v[244:245] op_sel_hi:[1,0]
    v_pk_fma_f32 v[120:121], v[228:229], v[242:243], v[120:121] op_sel_hi:[1,0,1]
    v_pk_fma_f32 v[122:123], v[230:231], v[242:243], v[122:123] op_sel_hi:[1,0,1]
    v_pk_fma_f32 v[124:125], v[228:229], v[246:247], v[124:125] op_sel_hi:[1,0,1]
    v_pk_fma_f32 v[126:127], v[230:231], v[246:247], v[126:127] op_sel_hi:[1,0,1]
    v_exp_f32 v128, v128
    v_exp_f32 v129, v129
    v_exp_f32 v130, v130
    v_exp_f32 v131, v131
    v_exp_f32 v132, v132
    v_exp_f32 v133, v133
    v_exp_f32 v134, v134
    v_exp_f32 v135, v135
    v_pk_mul_f32 v[136:137], v[104:105], v[120:121]
    v_pk_mul_f32 v[138:139], v[106:107], v[122:123]
    v_pk_mul_f32 v[140:141], v[108:109], v[124:125]
    v_pk_mul_f32 v[142:143], v[110:111], v[126:127]
    v_pk_fma_f32 v[128:129], v[128:129], v[240:241], v[240:241] op_sel:[0,1,1] op_sel_hi:[1,1,1]
    v_pk_fma_f32 v[130:131], v[130:131], v[240:241], v[240:241] op_sel:[0,1,1] op_sel_hi:[1,1,1]
    v_pk_fma_f32 v[132:133], v[132:133], v[244:245], v[244:245] op_sel:[0,1,1] op_sel_hi:[1,1,1]
    v_pk_fma_f32 v[134:135], v[134:135], v[244:245], v[244:245] op_sel:[0,1,1] op_sel_hi:[1,1,1]
    v_rcp_f32 v128, v128
    v_rcp_f32 v129, v129
    v_rcp_f32 v130, v130
    v_rcp_f32 v131, v131
    v_rcp_f32 v132, v132
    v_rcp_f32 v133, v133
    v_rcp_f32 v134, v134
    v_rcp_f32 v135, v135
    v_pk_mul_f32 v[136:137], v[136:137], v[128:129]
    v_pk_mul_f32 v[138:139], v[138:139], v[130:131]
    v_pk_mul_f32 v[140:141], v[140:141], v[132:133]
    v_pk_mul_f32 v[142:143], v[142:143], v[134:135]
    v_cvt_pk_bf16_f32 v200, v136, v137
    v_cvt_pk_bf16_f32 v201, v138, v139
    v_cvt_pk_bf16_f32 v202, v140, v141
    v_cvt_pk_bf16_f32 v203, v142, v143
    s_add_u32 s59, s58, 2
    s_cmp_ge_u32 s59, 86
    v_permlane16_swap_b32 v200, v202
    v_permlane16_swap_b32 v201, v203
    s_cbranch_scc1 Lhs17
    s_add_u32 s59, s57, 90112
    buffer_store_dwordx4 v[200:203], v2, s[40:43], s59 offen sc1
Lhs17:
    s_mov_b32 s50, s57
    s_lshl_b32 s54, s56, 5
    s_lshl_b32 s58, s7, 1
    s_add_u32 s54, s54, s58
    s_add_u32 s54, s54, s61
    s_lshl_b32 s54, s54, 2
    s_add_u32 s54, s54, 12288
L_conv:
    s_mul_i32 s58, s61, 17408
    s_add_u32 s58, s58, 122880
    s_lshl_b32 s59, s60, 8
    s_sub_u32 s59, s58, s59
    v_and_b32 v10, 15, v0
    v_lshrrev_b32 v11, 4, v0
    v_and_b32 v18, 1, v0
    v_cmp_eq_u32 vcc, 1, v18
    v_sub_u32 v18, 2032, v10
    v_lshrrev_b32 v18, 1, v18
    v_lshl_add_u32 v18, v11, 2, v18
    v_lshlrev_b32 v18, 2, v18
    v_mov_b32 v19, 4160
    v_cndmask_b32 v19, v19, 0, vcc
    v_add3_u32 v18, v18, v19, s59
    v_subrev_u32 v4, 704, v18
    v_subrev_u32 v5, 1728, v18
    v_subrev_u32 v6, 2752, v18
    v_subrev_u32 v7, 3776, v18
    v_lshlrev_b32 v8, 5, v10
    v_lshl_add_u32 v8, v11, 4, v8
    v_add_u32 v8, s59, v8
    v_add_u32 v8, 8608, v8
Lw18:
    ds_read_b32 v16, v15 offset:32
    s_waitcnt lgkmcnt(0)
    v_readfirstlane_b32 s67, v16
    s_nop 0
    s_cmp_lg_u32 s67, 0
    s_cbranch_scc1 Lw18d
    s_sub_u32 s55, s55, 1
    s_max_i32 s55, s55, 0
    s_cmp_lg_u32 s55, 0
    s_cbranch_scc1 Lw18
Lw18d:
    s_mov_b32 s52, s67
    v_mov_b32 v20, s52
    v_mov_b32 v21, 0
    s_mov_b32 s49, s32
Lw19:
    ds_read_b64 v[16:17], v15 offset:72
    s_waitcnt lgkmcnt(0)
    v_min_u32 v16, v16, v17
    s_nop 0
    v_readfirstlane_b32 s67, v16
    s_nop 0
    s_cmp_lg_u32 s67, 0
    s_cbranch_scc1 Lw19d
    s_sub_u32 s55, s55, 1
    s_max_i32 s55, s55, 0
    s_cmp_lg_u32 s55, 0
    s_cbranch_scc1 Lw19
Lw19d:
    ds_read2_b32 v[64:65], v4 offset0:176 offset1:177
    ds_read2_b32 v[66:67], v4 offset0:178 offset1:179
    ds_read_b128 v[96:99], v8 offset:192
    ds_read2_b32 v[68:69], v4 offset0:48 offset1:49
    ds_read2_b32 v[70:71], v4 offset0:50 offset1:51
    ds_read_b128 v[100:103], v8 offset:704
    ds_read2_b32 v[72:73], v5 offset0:176 offset1:177
    ds_read2_b32 v[74:75], v5 offset0:178 offset1:179
    ds_read_b128 v[104:107], v8 offset:1216
    ds_read2_b32 v[76:77], v5 offset0:48 offset1:49
    ds_read2_b32 v[78:79], v5 offset0:50 offset1:51
    ds_read_b128 v[108:111], v8 offset:1728
    ds_read2_b32 v[80:81], v6 offset0:176 offset1:177
    ds_read2_b32 v[82:83], v6 offset0:178 offset1:179
    ds_read_b128 v[112:115], v8 offset:2240
    ds_read2_b32 v[84:85], v6 offset0:48 offset1:49
    ds_read2_b32 v[86:87], v6 offset0:50 offset1:51
    ds_read_b128 v[116:119], v8 offset:2752
    ds_read2_b32 v[88:89], v7 offset0:176 offset1:177
    ds_read2_b32 v[90:91], v7 offset0:178 offset1:179
    ds_read_b128 v[120:123], v8 offset:3264
    ds_read2_b32 v[92:93], v7 offset0:48 offset1:49
    ds_read2_b32 v[94:95], v7 offset0:50 offset1:51
    ds_read_b128 v[124:127], v8 offset:3776
    s_waitcnt lgkmcnt(0)
    v_mfma_f32_16x16x32_bf16 v[32:35], v[64:67], v[96:99], 0
    ds_read2_b32 v[128:129], v4 offset0:160 offset1:161
    v_mfma_f32_16x16x32_bf16 v[36:39], v[64:67], v[100:103], 0
    ds_read2_b32 v[130:131], v4 offset0:162 offset1:163
    v_mfma_f32_16x16x32_bf16 v[40:43], v[64:67], v[104:107], 0
    ds_read_b128 v[160:163], v8 offset:128
    v_mfma_f32_16x16x32_bf16 v[44:47], v[64:67], v[108:111], 0
    ds_read2_b32 v[132:133], v4 offset0:32 offset1:33
    v_mfma_f32_16x16x32_bf16 v[48:51], v[64:67], v[112:115], 0
    ds_read2_b32 v[134:135], v4 offset0:34 offset1:35
    v_mfma_f32_16x16x32_bf16 v[52:55], v[64:67], v[116:119], 0
    ds_read_b128 v[164:167], v8 offset:640
    v_mfma_f32_16x16x32_bf16 v[56:59], v[64:67], v[120:123], 0
    ds_read2_b32 v[136:137], v5 offset0:160 offset1:161
    v_mfma_f32_16x16x32_bf16 v[60:63], v[64:67], v[124:127], 0
    ds_read2_b32 v[138:139], v5 offset0:162 offset1:163
    v_mfma_f32_16x16x32_bf16 v[36:39], v[68:71], v[96:99], v[36:39]
    ds_read_b128 v[168:171], v8 offset:1152
    v_mfma_f32_16x16x32_bf16 v[40:43], v[68:71], v[100:103], v[40:43]
    ds_read2_b32 v[140:141], v5 offset0:32 offset1:33
    v_mfma_f32_16x16x32_bf16 v[44:47], v[68:71], v[104:107], v[44:47]
    ds_read2_b32 v[142:143], v5 offset0:34 offset1:35
    v_mfma_f32_16x16x32_bf16 v[48:51], v[68:71], v[108:111], v[48:51]
    ds_read_b128 v[172:175], v8 offset:1664
    s_getreg_b32 s62, hwreg(HW_REG_IB_STS, 0, 4)
    s_or_b32 s62, s62, s49
    s_cbranch_scc1 Lhf20
    s_mov_b32 s49, 1
    s_add_u32 s62, s54, 4096
    s_waitcnt vmcnt(0)
    s_mov_b64 exec, 1
    buffer_store_dword v20, v21, s[40:43], s54 offen
    buffer_store_dword v20, v21, s[40:43], s62 offen sc1
    s_mov_b64 exec, -1
    ds_write_b32 v13, v20 offset:208
Lhf20:
    v_mfma_f32_16x16x32_bf16 v[52:55], v[68:71], v[112:115], v[52:55]
    ds_read2_b32 v[144:145], v6 offset0:160 offset1:161
    v_mfma_f32_16x16x32_bf16 v[56:59], v[68:71], v[116:119], v[56:59]
    ds_read2_b32 v[146:147], v6 offset0:162 offset1:163
    v_mfma_f32_16x16x32_bf16 v[60:63], v[68:71], v[120:123], v[60:63]
    ds_read_b128 v[176:179], v8 offset:2176
    v_mfma_f32_16x16x32_bf16 v[40:43], v[72:75], v[96:99], v[40:43]
    ds_read2_b32 v[148:149], v6 offset0:32 offset1:33
    v_mfma_f32_16x16x32_bf16 v[44:47], v[72:75], v[100:103], v[44:47]
    ds_read2_b32 v[150:151], v6 offset0:34 offset1:35
    v_mfma_f32_16x16x32_bf16 v[48:51], v[72:75], v[104:107], v[48:51]
    ds_read_b128 v[180:183], v8 offset:2688
    v_mfma_f32_16x16x32_bf16 v[52:55], v[72:75], v[108:111], v[52:55]
    ds_read2_b32 v[152:153], v7 offset0:160 offset1:161
    v_mfma_f32_16x16x32_bf16 v[56:59], v[72:75], v[112:115], v[56:59]
    ds_read2_b32 v[154:155], v7 offset0:162 offset1:163
    v_mfma_f32_16x16x32_bf16 v[60:63], v[72:75], v[116:119], v[60:63]
    ds_read_b128 v[184:187], v8 offset:3200
    v_mfma_f32_16x16x32_bf16 v[44:47], v[76:79], v[96:99], v[44:47]
    ds_read2_b32 v[156:157], v7 offset0:32 offset1:33
    v_mfma_f32_16x16x32_bf16 v[48:51], v[76:79], v[100:103], v[48:51]
    ds_read2_b32 v[158:159], v7 offset0:34 offset1:35
    v_mfma_f32_16x16x32_bf16 v[52:55], v[76:79], v[104:107], v[52:55]
    ds_read_b128 v[188:191], v8 offset:3712
    s_getreg_b32 s62, hwreg(HW_REG_IB_STS, 0, 4)
    s_or_b32 s62, s62, s49
    s_cbranch_scc1 Lhf21
    s_mov_b32 s49, 1
    s_add_u32 s62, s54, 4096
    s_waitcnt vmcnt(0)
    s_mov_b64 exec, 1
    buffer_store_dword v20, v21, s[40:43], s54 offen
    buffer_store_dword v20, v21, s[40:43], s62 offen sc1
    s_mov_b64 exec, -1
    ds_write_b32 v13, v20 offset:208
Lhf21:
    v_mfma_f32_16x16x32_bf16 v[56:59], v[76:79], v[108:111], v[56:59]
    v_mfma_f32_16x16x32_bf16 v[60:63], v[76:79], v[112:115], v[60:63]
    v_mfma_f32_16x16x32_bf16 v[48:51], v[80:83], v[96:99], v[48:51]
    v_mfma_f32_16x16x32_bf16 v[52:55], v[80:83], v[100:103], v[52:55]
    v_mfma_f32_16x16x32_bf16 v[56:59], v[80:83], v[104:107], v[56:59]
    v_mfma_f32_16x16x32_bf16 v[60:63], v[80:83], v[108:111], v[60:63]
    v_mfma_f32_16x16x32_bf16 v[52:55], v[84:87], v[96:99], v[52:55]
    v_mfma_f32_16x16x32_bf16 v[56:59], v[84:87], v[100:103], v[56:59]
    v_mfma_f32_16x16x32_bf16 v[60:63], v[84:87], v[104:107], v[60:63]
    v_mfma_f32_16x16x32_bf16 v[56:59], v[88:91], v[96:99], v[56:59]
    v_mfma_f32_16x16x32_bf16 v[60:63], v[88:91], v[100:103], v[60:63]
    v_mfma_f32_16x16x32_bf16 v[60:63], v[92:95], v[96:99], v[60:63]
    s_getreg_b32 s62, hwreg(HW_REG_IB_STS, 0, 4)
    s_or_b32 s62, s62, s49
    s_cbranch_scc1 Lhf22
    s_mov_b32 s49, 1
    s_add_u32 s62, s54, 4096
    s_waitcnt vmcnt(0)
    s_mov_b64 exec, 1
    buffer_store_dword v20, v21, s[40:43], s54 offen
    buffer_store_dword v20, v21, s[40:43], s62 offen sc1
    s_mov_b64 exec, -1
    ds_write_b32 v13, v20 offset:208
Lhf22:
    s_waitcnt lgkmcnt(0)
    v_mfma_f32_16x16x32_bf16 v[32:35], v[128:131], v[160:163], v[32:35]
    ds_read2_b32 v[64:65], v4 offset0:144 offset1:145
    v_mfma_f32_16x16x32_bf16 v[36:39], v[128:131], v[164:167], v[36:39]
    ds_read2_b32 v[66:67], v4 offset0:146 offset1:147
    v_mfma_f32_16x16x32_bf16 v[40:43], v[128:131], v[168:171], v[40:43]
    ds_read_b128 v[96:99], v8 offset:64
    v_mfma_f32_16x16x32_bf16 v[44:47], v[128:131], v[172:175], v[44:47]
    ds_read2_b32 v[68:69], v4 offset0:16 offset1:17
    v_mfma_f32_16x16x32_bf16 v[48:51], v[128:131], v[176:179], v[48:51]
    ds_read2_b32 v[70:71], v4 offset0:18 offset1:19
    v_mfma_f32_16x16x32_bf16 v[52:55], v[128:131], v[180:183], v[52:55]
    ds_read_b128 v[100:103], v8 offset:576
    v_mfma_f32_16x16x32_bf16 v[56:59], v[128:131], v[184:187], v[56:59]
    ds_read2_b32 v[72:73], v5 offset0:144 offset1:145
    v_mfma_f32_16x16x32_bf16 v[60:63], v[128:131], v[188:191], v[60:63]
    ds_read2_b32 v[74:75], v5 offset0:146 offset1:147
    v_mfma_f32_16x16x32_bf16 v[36:39], v[132:135], v[160:163], v[36:39]
    ds_read_b128 v[104:107], v8 offset:1088
    v_mfma_f32_16x16x32_bf16 v[40:43], v[132:135], v[164:167], v[40:43]
    ds_read2_b32 v[76:77], v5 offset0:16 offset1:17
    v_mfma_f32_16x16x32_bf16 v[44:47], v[132:135], v[168:171], v[44:47]
    ds_read2_b32 v[78:79], v5 offset0:18 offset1:19
    v_mfma_f32_16x16x32_bf16 v[48:51], v[132:135], v[172:175], v[48:51]
    ds_read_b128 v[108:111], v8 offset:1600
    s_getreg_b32 s62, hwreg(HW_REG_IB_STS, 0, 4)
    s_or_b32 s62, s62, s49
    s_cbranch_scc1 Lhf23
    s_mov_b32 s49, 1
    s_add_u32 s62, s54, 4096
    s_waitcnt vmcnt(0)
    s_mov_b64 exec, 1
    buffer_store_dword v20, v21, s[40:43], s54 offen
    buffer_store_dword v20, v21, s[40:43], s62 offen sc1
    s_mov_b64 exec, -1
    ds_write_b32 v13, v20 offset:208
Lhf23:
    v_mfma_f32_16x16x32_bf16 v[52:55], v[132:135], v[176:179], v[52:55]
    ds_read2_b32 v[80:81], v6 offset0:144 offset1:145
    v_mfma_f32_16x16x32_bf16 v[56:59], v[132:135], v[180:183], v[56:59]
    ds_read2_b32 v[82:83], v6 offset0:146 offset1:147
    v_mfma_f32_16x16x32_bf16 v[60:63], v[132:135], v[184:187], v[60:63]
    ds_read_b128 v[112:115], v8 offset:2112
    v_mfma_f32_16x16x32_bf16 v[40:43], v[136:139], v[160:163], v[40:43]
    ds_read2_b32 v[84:85], v6 offset0:16 offset1:17
    v_mfma_f32_16x16x32_bf16 v[44:47], v[136:139], v[164:167], v[44:47]
    ds_read2_b32 v[86:87], v6 offset0:18 offset1:19
    v_mfma_f32_16x16x32_bf16 v[48:51], v[136:139], v[168:171], v[48:51]
    ds_read_b128 v[116:119], v8 offset:2624
    v_mfma_f32_16x16x32_bf16 v[52:55], v[136:139], v[172:175], v[52:55]
    ds_read2_b32 v[88:89], v7 offset0:144 offset1:145
    v_mfma_f32_16x16x32_bf16 v[56:59], v[136:139], v[176:179], v[56:59]
    ds_read2_b32 v[90:91], v7 offset0:146 offset1:147
    v_mfma_f32_16x16x32_bf16 v[60:63], v[136:139], v[180:183], v[60:63]
    ds_read_b128 v[120:123], v8 offset:3136
    v_mfma_f32_16x16x32_bf16 v[44:47], v[140:143], v[160:163], v[44:47]
    ds_read2_b32 v[92:93], v7 offset0:16 offset1:17
    v_mfma_f32_16x16x32_bf16 v[48:51], v[140:143], v[164:167], v[48:51]
    ds_read2_b32 v[94:95], v7 offset0:18 offset1:19
    v_mfma_f32_16x16x32_bf16 v[52:55], v[140:143], v[168:171], v[52:55]
    ds_read_b128 v[124:127], v8 offset:3648
    s_getreg_b32 s62, hwreg(HW_REG_IB_STS, 0, 4)
    s_or_b32 s62, s62, s49
    s_cbranch_scc1 Lhf24
    s_mov_b32 s49, 1
    s_add_u32 s62, s54, 4096
    s_waitcnt vmcnt(0)
    s_mov_b64 exec, 1
    buffer_store_dword v20, v21, s[40:43], s54 offen
    buffer_store_dword v20, v21, s[40:43], s62 offen sc1
    s_mov_b64 exec, -1
    ds_write_b32 v13, v20 offset:208
Lhf24:
    v_mfma_f32_16x16x32_bf16 v[56:59], v[140:143], v[172:175], v[56:59]
    v_mfma_f32_16x16x32_bf16 v[60:63], v[140:143], v[176:179], v[60:63]
    v_mfma_f32_16x16x32_bf16 v[48:51], v[144:147], v[160:163], v[48:51]
    v_mfma_f32_16x16x32_bf16 v[52:55], v[144:147], v[164:167], v[52:55]
    v_mfma_f32_16x16x32_bf16 v[56:59], v[144:147], v[168:171], v[56:59]
    v_mfma_f32_16x16x32_bf16 v[60:63], v[144:147], v[172:175], v[60:63]
    v_mfma_f32_16x16x32_bf16 v[52:55], v[148:151], v[160:163], v[52:55]
    v_mfma_f32_16x16x32_bf16 v[56:59], v[148:151], v[164:167], v[56:59]
    v_mfma_f32_16x16x32_bf16 v[60:63], v[148:151], v[168:171], v[60:63]
    v_mfma_f32_16x16x32_bf16 v[56:59], v[152:155], v[160:163], v[56:59]
    v_mfma_f32_16x16x32_bf16 v[60:63], v[152:155], v[164:167], v[60:63]
    v_mfma_f32_16x16x32_bf16 v[60:63], v[156:159], v[160:163], v[60:63]
    s_getreg_b32 s62, hwreg(HW_REG_IB_STS, 0, 4)
    s_or_b32 s62, s62, s49
    s_cbranch_scc1 Lhf25
    s_mov_b32 s49, 1
    s_add_u32 s62, s54, 4096
    s_waitcnt vmcnt(0)
    s_mov_b64 exec, 1
    buffer_store_dword v20, v21, s[40:43], s54 offen
    buffer_store_dword v20, v21, s[40:43], s62 offen sc1
    s_mov_b64 exec, -1
    ds_write_b32 v13, v20 offset:208
Lhf25:
    s_waitcnt lgkmcnt(0)
    v_mfma_f32_16x16x32_bf16 v[32:35], v[64:67], v[96:99], v[32:35]
    ds_read2_b32 v[128:129], v4 offset0:128 offset1:129
    v_mfma_f32_16x16x32_bf16 v[36:39], v[64:67], v[100:103], v[36:39]
    ds_read2_b32 v[130:131], v4 offset0:130 offset1:131
    v_mfma_f32_16x16x32_bf16 v[40:43], v[64:67], v[104:107], v[40:43]
    ds_read_b128 v[160:163], v8 offset:0
    v_mfma_f32_16x16x32_bf16 v[44:47], v[64:67], v[108:111], v[44:47]
    ds_read2_b32 v[132:133], v4 offset0:0 offset1:1
    v_mfma_f32_16x16x32_bf16 v[48:51], v[64:67], v[112:115], v[48:51]
    ds_read2_b32 v[134:135], v4 offset0:2 offset1:3
    v_mfma_f32_16x16x32_bf16 v[52:55], v[64:67], v[116:119], v[52:55]
    ds_read_b128 v[164:167], v8 offset:512
    v_mfma_f32_16x16x32_bf16 v[56:59], v[64:67], v[120:123], v[56:59]
    ds_read2_b32 v[136:137], v5 offset0:128 offset1:129
    v_mfma_f32_16x16x32_bf16 v[60:63], v[64:67], v[124:127], v[60:63]
    ds_read2_b32 v[138:139], v5 offset0:130 offset1:131
    v_mfma_f32_16x16x32_bf16 v[36:39], v[68:71], v[96:99], v[36:39]
    ds_read_b128 v[168:171], v8 offset:1024
    v_mfma_f32_16x16x32_bf16 v[40:43], v[68:71], v[100:103], v[40:43]
    ds_read2_b32 v[140:141], v5 offset0:0 offset1:1
    v_mfma_f32_16x16x32_bf16 v[44:47], v[68:71], v[104:107], v[44:47]
    ds_read2_b32 v[142:143], v5 offset0:2 offset1:3
    v_mfma_f32_16x16x32_bf16 v[48:51], v[68:71], v[108:111], v[48:51]
    ds_read_b128 v[172:175], v8 offset:1536
    s_getreg_b32 s62, hwreg(HW_REG_IB_STS, 0, 4)
    s_or_b32 s62, s62, s49
    s_cbranch_scc1 Lhf26
    s_mov_b32 s49, 1
    s_add_u32 s62, s54, 4096
    s_waitcnt vmcnt(0)
    s_mov_b64 exec, 1
    buffer_store_dword v20, v21, s[40:43], s54 offen
    buffer_store_dword v20, v21, s[40:43], s62 offen sc1
    s_mov_b64 exec, -1
    ds_write_b32 v13, v20 offset:208
Lhf26:
    v_mfma_f32_16x16x32_bf16 v[52:55], v[68:71], v[112:115], v[52:55]
    ds_read2_b32 v[144:145], v6 offset0:128 offset1:129
    v_mfma_f32_16x16x32_bf16 v[56:59], v[68:71], v[116:119], v[56:59]
    ds_read2_b32 v[146:147], v6 offset0:130 offset1:131
    v_mfma_f32_16x16x32_bf16 v[60:63], v[68:71], v[120:123], v[60:63]
    ds_read_b128 v[176:179], v8 offset:2048
    v_mfma_f32_16x16x32_bf16 v[40:43], v[72:75], v[96:99], v[40:43]
    ds_read2_b32 v[148:149], v6 offset0:0 offset1:1
    v_mfma_f32_16x16x32_bf16 v[44:47], v[72:75], v[100:103], v[44:47]
    ds_read2_b32 v[150:151], v6 offset0:2 offset1:3
    v_mfma_f32_16x16x32_bf16 v[48:51], v[72:75], v[104:107], v[48:51]
    ds_read_b128 v[180:183], v8 offset:2560
    v_mfma_f32_16x16x32_bf16 v[52:55], v[72:75], v[108:111], v[52:55]
    ds_read2_b32 v[152:153], v7 offset0:128 offset1:129
    v_mfma_f32_16x16x32_bf16 v[56:59], v[72:75], v[112:115], v[56:59]
    ds_read2_b32 v[154:155], v7 offset0:130 offset1:131
    v_mfma_f32_16x16x32_bf16 v[60:63], v[72:75], v[116:119], v[60:63]
    ds_read_b128 v[184:187], v8 offset:3072
    v_mfma_f32_16x16x32_bf16 v[44:47], v[76:79], v[96:99], v[44:47]
    ds_read2_b32 v[156:157], v7 offset0:0 offset1:1
    v_mfma_f32_16x16x32_bf16 v[48:51], v[76:79], v[100:103], v[48:51]
    ds_read2_b32 v[158:159], v7 offset0:2 offset1:3
    v_mfma_f32_16x16x32_bf16 v[52:55], v[76:79], v[104:107], v[52:55]
    ds_read_b128 v[188:191], v8 offset:3584
    s_getreg_b32 s62, hwreg(HW_REG_IB_STS, 0, 4)
    s_or_b32 s62, s62, s49
    s_cbranch_scc1 Lhf27
    s_mov_b32 s49, 1
    s_add_u32 s62, s54, 4096
    s_waitcnt vmcnt(0)
    s_mov_b64 exec, 1
    buffer_store_dword v20, v21, s[40:43], s54 offen
    buffer_store_dword v20, v21, s[40:43], s62 offen sc1
    s_mov_b64 exec, -1
    ds_write_b32 v13, v20 offset:208
Lhf27:
    v_mfma_f32_16x16x32_bf16 v[56:59], v[76:79], v[108:111], v[56:59]
    v_mfma_f32_16x16x32_bf16 v[60:63], v[76:79], v[112:115], v[60:63]
    v_mfma_f32_16x16x32_bf16 v[48:51], v[80:83], v[96:99], v[48:51]
    v_mfma_f32_16x16x32_bf16 v[52:55], v[80:83], v[100:103], v[52:55]
    v_mfma_f32_16x16x32_bf16 v[56:59], v[80:83], v[104:107], v[56:59]
    v_mfma_f32_16x16x32_bf16 v[60:63], v[80:83], v[108:111], v[60:63]
    v_mfma_f32_16x16x32_bf16 v[52:55], v[84:87], v[96:99], v[52:55]
    v_mfma_f32_16x16x32_bf16 v[56:59], v[84:87], v[100:103], v[56:59]
    v_mfma_f32_16x16x32_bf16 v[60:63], v[84:87], v[104:107], v[60:63]
    v_mfma_f32_16x16x32_bf16 v[56:59], v[88:91], v[96:99], v[56:59]
    v_mfma_f32_16x16x32_bf16 v[60:63], v[88:91], v[100:103], v[60:63]
    v_mfma_f32_16x16x32_bf16 v[60:63], v[92:95], v[96:99], v[60:63]
    s_cmp_lg_u32 s49, 0
    s_cbranch_scc1 Lhf28
    s_mov_b32 s49, 1
    s_add_u32 s62, s54, 4096
    s_waitcnt vmcnt(0)
    s_mov_b64 exec, 1
    buffer_store_dword v20, v21, s[40:43], s54 offen
    buffer_store_dword v20, v21, s[40:43], s62 offen sc1
    s_mov_b64 exec, -1
    ds_write_b32 v13, v20 offset:208
Lhf28:
    s_waitcnt lgkmcnt(0)
    v_mov_b32 v12, 1
    ds_write_b32 v13, v12 offset:80
    v_mfma_f32_16x16x32_bf16 v[32:35], v[128:131], v[160:163], v[32:35]
    s_xor_b32 s59, s3, 1
    v_mfma_f32_16x16x32_bf16 v[36:39], v[128:131], v[164:167], v[36:39]
    s_lshl_b32 s59, s59, 2
    v_mfma_f32_16x16x32_bf16 v[40:43], v[128:131], v[168:171], v[40:43]
    v_add_u32 v9, s59, v15
    v_mfma_f32_16x16x32_bf16 v[44:47], v[128:131], v[172:175], v[44:47]
    v_lshlrev_b32 v5, 4, v0
    v_mfma_f32_16x16x32_bf16 v[48:51], v[128:131], v[176:179], v[48:51]
    s_lshl_b32 s59, s60, 12
    v_mfma_f32_16x16x32_bf16 v[52:55], v[128:131], v[180:183], v[52:55]
    s_add_u32 s59, s59, s58
    v_mfma_f32_16x16x32_bf16 v[56:59], v[128:131], v[184:187], v[56:59]
    v_add_u32 v6, s59, v5
    v_mfma_f32_16x16x32_bf16 v[60:63], v[128:131], v[188:191], v[60:63]
    v_xor_b32 v7, 4096, v5
    v_mfma_f32_16x16x32_bf16 v[36:39], v[132:135], v[160:163], v[36:39]
    s_lshl_b32 s59, s60, 12
    v_mfma_f32_16x16x32_bf16 v[40:43], v[132:135], v[164:167], v[40:43]
    v_xor_b32 v7, s59, v7
    v_mfma_f32_16x16x32_bf16 v[44:47], v[132:135], v[168:171], v[44:47]
    v_add_u32 v7, s58, v7
    v_mfma_f32_16x16x32_bf16 v[48:51], v[132:135], v[172:175], v[48:51]
    s_lshl_b32 s56, s53, 1
    v_mfma_f32_16x16x32_bf16 v[52:55], v[132:135], v[176:179], v[52:55]
    s_add_u32 s56, s56, s61
    v_mfma_f32_16x16x32_bf16 v[56:59], v[132:135], v[180:183], v[56:59]
    s_lshl_b32 s57, s56, 8
    v_mfma_f32_16x16x32_bf16 v[60:63], v[132:135], v[184:187], v[60:63]
    s_lshl_b32 s59, s60, 21
    v_mfma_f32_16x16x32_bf16 v[40:43], v[136:139], v[160:163], v[40:43]
    s_add_u32 s57, s57, s59
    v_mfma_f32_16x16x32_bf16 v[44:47], v[136:139], v[164:167], v[44:47]
    s_add_u32 s57, s57, 12582912
    v_mfma_f32_16x16x32_bf16 v[48:51], v[136:139], v[168:171], v[48:51]
    v_lshlrev_b32 v4, 17, v11
    v_mfma_f32_16x16x32_bf16 v[52:55], v[136:139], v[172:175], v[52:55]
    v_lshl_add_u32 v4, v10, 4, v4
    v_mfma_f32_16x16x32_bf16 v[56:59], v[136:139], v[176:179], v[56:59]
    v_and_b32 v2, 3, v0
    v_mfma_f32_16x16x32_bf16 v[60:63], v[136:139], v[180:183], v[60:63]
    v_lshlrev_b32 v2, 6, v2
    v_mfma_f32_16x16x32_bf16 v[44:47], v[140:143], v[160:163], v[44:47]
    v_and_b32 v3, 60, v0
    v_mfma_f32_16x16x32_bf16 v[48:51], v[140:143], v[164:167], v[48:51]
    v_add_u32 v2, v2, v3
    v_mfma_f32_16x16x32_bf16 v[52:55], v[140:143], v[168:171], v[52:55]
    v_mov_b32 v193, s52
    v_mfma_f32_16x16x32_bf16 v[56:59], v[140:143], v[172:175], v[56:59]
    v_mov_b32 v195, s52
    v_mfma_f32_16x16x32_bf16 v[60:63], v[140:143], v[176:179], v[60:63]
    v_mov_b32 v197, s52
    v_mfma_f32_16x16x32_bf16 v[48:51], v[144:147], v[160:163], v[48:51]
    v_mov_b32 v199, s52
    v_mfma_f32_16x16x32_bf16 v[52:55], v[144:147], v[164:167], v[52:55]
    v_mov_b32 v201, s52
    v_mfma_f32_16x16x32_bf16 v[56:59], v[144:147], v[168:171], v[56:59]
    v_mov_b32 v203, s52
    v_mfma_f32_16x16x32_bf16 v[60:63], v[144:147], v[172:175], v[60:63]
    v_mov_b32 v205, s52
    v_mfma_f32_16x16x32_bf16 v[52:55], v[148:151], v[160:163], v[52:55]
    v_mov_b32 v207, s52
    v_mfma_f32_16x16x32_bf16 v[56:59], v[148:151], v[164:167], v[56:59]
    ds_read_b32 v16, v9 offset:80
    v_mfma_f32_16x16x32_bf16 v[60:63], v[148:151], v[168:171], v[60:63]
    v_mfma_f32_16x16x32_bf16 v[56:59], v[152:155], v[160:163], v[56:59]
    v_mfma_f32_16x16x32_bf16 v[60:63], v[152:155], v[164:167], v[60:63]
    v_mfma_f32_16x16x32_bf16 v[60:63], v[156:159], v[160:163], v[60:63]
Lv29:
    s_waitcnt lgkmcnt(0)
    v_cmp_gt_u32 vcc, 1, v16
    s_nop 0
    s_cbranch_vccz Lv29d
    ds_read_b32 v16, v9 offset:80
    s_sub_u32 s55, s55, 1
    s_max_i32 s55, s55, 0
    s_cmp_lg_u32 s55, 0
    s_cbranch_scc1 Lv29
Lv29d:
    s_nop 1
    s_cmp_eq_u32 s60, 0
    s_cbranch_scc1 L_cx0
    ds_write_b128 v6, v[32:35] offset:0
    ds_write_b128 v6, v[36:39] offset:1024
    ds_write_b128 v6, v[40:43] offset:2048
    ds_write_b128 v6, v[44:47] offset:3072
    v_mov_b32 v32, v48
    v_mov_b32 v33, v49
    v_mov_b32 v34, v50
    v_mov_b32 v35, v51
    v_mov_b32 v36, v52
    v_mov_b32 v37, v53
    v_mov_b32 v38, v54
    v_mov_b32 v39, v55
    v_mov_b32 v40, v56
    v_mov_b32 v41, v57
    v_mov_b32 v42, v58
    v_mov_b32 v43, v59
    v_mov_b32 v44, v60
    v_mov_b32 v45, v61
    v_mov_b32 v46, v62
    v_mov_b32 v47, v63
    s_branch L_cx1
L_cx0:
    ds_write_b128 v6, v[48:51] offset:0
    ds_write_b128 v6, v[52:55] offset:1024
    ds_write_b128 v6, v[56:59] offset:2048
    ds_write_b128 v6, v[60:63] offset:3072
L_cx1:
    s_waitcnt lgkmcnt(0)
    ds_write_b32 v13, v12 offset:96
Lv30:
    ds_read_b32 v16, v9 offset:96
    s_waitcnt lgkmcnt(0)
    v_cmp_gt_u32 vcc, 1, v16
    s_nop 0
    s_cbranch_vccz Lv30d
    s_sub_u32 s55, s55, 1
    s_max_i32 s55, s55, 0
    s_cmp_lg_u32 s55, 0
    s_cbranch_scc1 Lv30
Lv30d:
    ds_read_b128 v[48:51], v7 offset:0
    ds_read_b128 v[52:55], v7 offset:1024
    ds_read_b128 v[56:59], v7 offset:2048
    ds_read_b128 v[60:63], v7 offset:3072
    s_waitcnt lgkmcnt(3)
    v_add_f32 v32, v32, v48
    v_add_f32 v33, v33, v49
    v_add_f32 v34, v34, v50
    v_add_f32 v35, v35, v51
    v_cvt_pk_bf16_f32 v240, v32, v33
    v_cvt_pk_bf16_f32 v241, v34, v35
    s_waitcnt lgkmcnt(2)
    v_add_f32 v36, v36, v52
    v_add_f32 v37, v37, v53
    v_add_f32 v38, v38, v54
    v_add_f32 v39, v39, v55
    v_cvt_pk_bf16_f32 v242, v36, v37
    v_cvt_pk_bf16_f32 v243, v38, v39
    s_waitcnt lgkmcnt(1)
    v_add_f32 v40, v40, v56
    v_add_f32 v41, v41, v57
    v_add_f32 v42, v42, v58
    v_add_f32 v43, v43, v59
    v_cvt_pk_bf16_f32 v244, v40, v41
    v_cvt_pk_bf16_f32 v245, v42, v43
    s_waitcnt lgkmcnt(0)
    v_add_f32 v44, v44, v60
    v_add_f32 v45, v45, v61
    v_add_f32 v46, v46, v62
    v_add_f32 v47, v47, v63
    v_cvt_pk_bf16_f32 v246, v44, v45
    v_cvt_pk_bf16_f32 v247, v46, v47
    ds_bpermute_b32 v192, v2, v240
    ds_bpermute_b32 v194, v2, v241
    ds_bpermute_b32 v196, v2, v242
    ds_bpermute_b32 v198, v2, v243
    ds_bpermute_b32 v200, v2, v244
    ds_bpermute_b32 v202, v2, v245
    ds_bpermute_b32 v204, v2, v246
    ds_bpermute_b32 v206, v2, v247
    s_waitcnt lgkmcnt(6)
    buffer_store_dwordx4 v[192:195], v4, s[40:43], s57 offen sc1
    s_add_u32 s57, s57, 524288
    s_waitcnt lgkmcnt(4)
    buffer_store_dwordx4 v[196:199], v4, s[40:43], s57 offen sc1
    s_add_u32 s57, s57, 524288
    s_waitcnt lgkmcnt(2)
    buffer_store_dwordx4 v[200:203], v4, s[40:43], s57 offen sc1
    s_add_u32 s57, s57, 524288
    s_waitcnt lgkmcnt(0)
    buffer_store_dwordx4 v[204:207], v4, s[40:43], s57 offen sc1
    s_add_u32 s57, s57, 524288
    s_mov_b32 s44, s30
    s_and_b32 s45, s31, 0xffff
    s_mov_b32 s46, 2097152
    s_mov_b32 s47, 0x00020000
    s_lshr_b32 s57, s5, 2
    s_xor_b32 s57, s57, 4
    s_lshl_b32 s58, s57, 2
    s_add_u32 s58, s58, s3
    s_lshl_b32 s63, s58, 12
    s_lshl_b32 s64, s33, 17
    s_add_u32 s63, s63, s64
    s_add_u32 s56, s63, 12582912
    s_mul_i32 s65, s61, 17408
    s_lshl_b32 s66, s60, 11
    s_add_u32 s65, s65, s66
    s_add_u32 s65, s65, 135808
    v_lshl_add_u32 v4, v0, 3, s65
    v_bfe_u32 v3, v0, 2, 2
    v_lshl_add_u32 v3, v11, 3, v3
    v_lshlrev_b32 v6, 7, v3
    v_and_b32 v3, 3, v0
    v_lshl_add_u32 v6, v3, 3, v6
    s_lshl_b32 s65, s3, 5
    s_add_u32 s65, s65, 135808
    v_add_u32 v6, s65, v6
    v_lshl_add_u32 v8, v3, 2, v15
    v_lshlrev_b32 v7, 10, v11
    v_lshl_add_u32 v7, v10, 4, v7
    s_lshl_b32 s65, s61, 13
    s_lshl_b32 s66, s60, 8
    s_add_u32 s65, s65, s66
    s_add_u32 s65, s65, 40960
    v_add_u32 v7, s65, v7
    v_and_b32 v9, 1, v0
    v_lshlrev_b32 v9, 3, v9
    s_lshl_b32 s65, s61, 2
    v_add3_u32 v9, v9, s65, v15
    v_add_u32 v18, 1024, v4
    s_waitcnt vmcnt(4)
    v_lshlrev_b32 v80, 16, v248
    v_and_b32 v81, 0xffff0000, v248
    v_lshlrev_b32 v82, 16, v249
    v_and_b32 v83, 0xffff0000, v249
    v_lshlrev_b32 v84, 16, v250
    v_and_b32 v85, 0xffff0000, v250
    v_lshlrev_b32 v86, 16, v251
    v_and_b32 v87, 0xffff0000, v251
    v_lshlrev_b32 v88, 16, v252
    v_and_b32 v89, 0xffff0000, v252
    v_lshlrev_b32 v90, 16, v253
    v_and_b32 v91, 0xffff0000, v253
    v_lshlrev_b32 v92, 16, v254
    v_and_b32 v93, 0xffff0000, v254
    v_lshlrev_b32 v94, 16, v255
    v_and_b32 v95, 0xffff0000, v255
Lv31:
    ds_read_b32 v16, v8 offset:176
    s_waitcnt lgkmcnt(0)
    v_cmp_gt_u32 vcc, 1, v16
    s_nop 0
    s_cbranch_vccz Lv31d
    s_sleep 2
    s_sub_u32 s55, s55, 1
    s_max_i32 s55, s55, 0
    s_cmp_lg_u32 s55, 0
    s_cbranch_scc1 Lv31
Lv31d:
L_s_fl:
    buffer_load_dwordx4 v[112:115], v5, s[40:43], s56 offen offset:0 sc1
    buffer_load_dwordx4 v[116:119], v5, s[40:43], s56 offen offset:1024 sc1
    buffer_load_dwordx4 v[120:123], v5, s[40:43], s56 offen offset:2048 sc1
    buffer_load_dwordx4 v[124:127], v5, s[40:43], s56 offen offset:3072 sc1
    s_waitcnt vmcnt(0)
    v_xor_b32 v64, s52, v113
    v_xor_b32 v65, s52, v115
    v_xor_b32 v66, s52, v117
    v_xor_b32 v67, s52, v119
    v_xor_b32 v68, s52, v121
    v_xor_b32 v69, s52, v123
    v_xor_b32 v70, s52, v125
    v_xor_b32 v71, s52, v127
    v_or3_b32 v64, v64, v65, v66
    v_or3_b32 v67, v67, v68, v69
    v_or3_b32 v64, v64, v70, v71
    v_or_b32 v64, v64, v67
    v_cmp_ne_u32 vcc, 0, v64
    s_nop 0
    s_cbranch_vccz L_s_fld
    s_sleep 6
    s_sub_u32 s55, s55, 1
    s_max_i32 s55, s55, 0
    s_cmp_lg_u32 s55, 0
    s_cbranch_scc1 L_s_fl
L_s_fld:
    ds_write2_b32 v4, v112, v114 offset0:0 offset1:1
    ds_write2_b32 v4, v116, v118 offset0:128 offset1:129
    ds_write2_b32 v18, v120, v122 offset0:0 offset1:1
    ds_write2_b32 v18, v124, v126 offset0:128 offset1:129
    s_waitcnt lgkmcnt(0)
    ds_write_b32 v13, v12 offset:112
Lv32:
    ds_read_b32 v16, v8 offset:112
    s_waitcnt lgkmcnt(0)
    v_cmp_gt_u32 vcc, 1, v16
    s_nop 0
    s_cbranch_vccz Lv32d
    s_sub_u32 s55, s55, 1
    s_max_i32 s55, s55, 0
    s_cmp_lg_u32 s55, 0
    s_cbranch_scc1 Lv32
Lv32d:
    ds_read_b64_tr_b16 v[72:73], v6 offset:0
    ds_read_b64_tr_b16 v[74:75], v6 offset:512
    ds_read_b64_tr_b16 v[76:77], v6 offset:17408
    ds_read_b64_tr_b16 v[78:79], v6 offset:17920
    s_mov_b32 s64, 3216550459
    s_mov_b32 s65, s64
    s_waitcnt lgkmcnt(0)
    v_lshlrev_b32 v96, 16, v72
    v_and_b32 v97, 0xffff0000, v72
    v_lshlrev_b32 v98, 16, v73
    v_and_b32 v99, 0xffff0000, v73
    v_lshlrev_b32 v100, 16, v74
    v_and_b32 v101, 0xffff0000, v74
    v_lshlrev_b32 v102, 16, v75
    v_and_b32 v103, 0xffff0000, v75
    v_lshlrev_b32 v104, 16, v76
    v_and_b32 v105, 0xffff0000, v76
    v_lshlrev_b32 v106, 16, v77
    v_and_b32 v107, 0xffff0000, v77
    v_lshlrev_b32 v108, 16, v78
    v_and_b32 v109, 0xffff0000, v78
    v_lshlrev_b32 v110, 16, v79
    v_and_b32 v111, 0xffff0000, v79
Lv33:
    ds_read_b32 v16, v9 offset:192
    s_waitcnt lgkmcnt(0)
    v_cmp_gt_u32 vcc, 1, v16
    s_nop 0
    s_cbranch_vccz Lv33d
    s_sub_u32 s55, s55, 1
    s_max_i32 s55, s55, 0
    s_cmp_lg_u32 s55, 0
    s_cbranch_scc1 Lv33
Lv33d:
    ds_read_b128 v[32:35], v7 offset:0
    ds_read_b128 v[48:51], v7 offset:20480
    ds_read_b128 v[36:39], v7 offset:512
    ds_read_b128 v[52:55], v7 offset:20992
    ds_read_b128 v[40:43], v7 offset:4096
    ds_read_b128 v[56:59], v7 offset:24576
    ds_read_b128 v[44:47], v7 offset:4608
    ds_read_b128 v[60:63], v7 offset:25088
    s_waitcnt lgkmcnt(6)
    v_pk_add_f32 v[32:33], v[32:33], v[48:49]
    v_pk_add_f32 v[34:35], v[34:35], v[50:51]
    v_pk_mul_f32 v[48:49], v[32:33], s[64:65]
    v_pk_mul_f32 v[50:51], v[34:35], s[64:65]
    v_exp_f32 v48, v48
    v_exp_f32 v49, v49
    v_exp_f32 v50, v50
    v_exp_f32 v51, v51
    s_waitcnt lgkmcnt(4)
    v_pk_add_f32 v[36:37], v[36:37], v[52:53]
    v_pk_add_f32 v[38:39], v[38:39], v[54:55]
    v_pk_mul_f32 v[52:53], v[36:37], s[64:65]
    v_pk_mul_f32 v[54:55], v[38:39], s[64:65]
    v_exp_f32 v52, v52
    v_exp_f32 v53, v53
    v_exp_f32 v54, v54
    v_exp_f32 v55, v55
    s_waitcnt lgkmcnt(2)
    v_pk_add_f32 v[40:41], v[40:41], v[56:57]
    v_pk_add_f32 v[42:43], v[42:43], v[58:59]
    v_pk_mul_f32 v[56:57], v[40:41], s[64:65]
    v_pk_mul_f32 v[58:59], v[42:43], s[64:65]
    v_exp_f32 v56, v56
    v_exp_f32 v57, v57
    v_exp_f32 v58, v58
    v_exp_f32 v59, v59
    s_waitcnt lgkmcnt(0)
    v_pk_add_f32 v[44:45], v[44:45], v[60:61]
    v_pk_add_f32 v[46:47], v[46:47], v[62:63]
    v_pk_mul_f32 v[60:61], v[44:45], s[64:65]
    v_pk_mul_f32 v[62:63], v[46:47], s[64:65]
    v_exp_f32 v60, v60
    v_exp_f32 v61, v61
    v_exp_f32 v62, v62
    v_exp_f32 v63, v63
    v_pk_add_f32 v[48:49], v[48:49], 1.0 op_sel_hi:[1,0]
    v_pk_add_f32 v[50:51], v[50:51], 1.0 op_sel_hi:[1,0]
    v_pk_add_f32 v[52:53], v[52:53], 1.0 op_sel_hi:[1,0]
    v_pk_add_f32 v[54:55], v[54:55], 1.0 op_sel_hi:[1,0]
    v_pk_mul_f32 v[32:33], v[32:33], v[96:97]
    v_pk_mul_f32 v[34:35], v[34:35], v[98:99]
    v_pk_mul_f32 v[36:37], v[36:37], v[100:101]
    v_pk_mul_f32 v[38:39], v[38:39], v[102:103]
    v_rcp_f32 v48, v48
    v_rcp_f32 v49, v49
    v_rcp_f32 v50, v50
    v_rcp_f32 v51, v51
    v_rcp_f32 v52, v52
    v_rcp_f32 v53, v53
    v_rcp_f32 v54, v54
    v_rcp_f32 v55, v55
    v_pk_fma_f32 v[32:33], v[32:33], v[48:49], v[80:81]
    v_pk_fma_f32 v[34:35], v[34:35], v[50:51], v[82:83]
    v_pk_fma_f32 v[36:37], v[36:37], v[52:53], v[84:85]
    v_pk_fma_f32 v[38:39], v[38:39], v[54:55], v[86:87]
    v_cvt_pk_bf16_f32 v64, v32, v33
    v_cvt_pk_bf16_f32 v65, v34, v35
    v_cvt_pk_bf16_f32 v66, v36, v37
    v_cvt_pk_bf16_f32 v67, v38, v39
    buffer_store_dwordx4 v[64:67], v31, s[44:47], s51 offen offset:0
    v_pk_add_f32 v[56:57], v[56:57], 1.0 op_sel_hi:[1,0]
    v_pk_add_f32 v[58:59], v[58:59], 1.0 op_sel_hi:[1,0]
    v_pk_add_f32 v[60:61], v[60:61], 1.0 op_sel_hi:[1,0]
    v_pk_add_f32 v[62:63], v[62:63], 1.0 op_sel_hi:[1,0]
    v_pk_mul_f32 v[40:41], v[40:41], v[104:105]
    v_pk_mul_f32 v[42:43], v[42:43], v[106:107]
    v_pk_mul_f32 v[44:45], v[44:45], v[108:109]
    v_pk_mul_f32 v[46:47], v[46:47], v[110:111]
    v_rcp_f32 v56, v56
    v_rcp_f32 v57, v57
    v_rcp_f32 v58, v58
    v_rcp_f32 v59, v59
    v_rcp_f32 v60, v60
    v_rcp_f32 v61, v61
    v_rcp_f32 v62, v62
    v_rcp_f32 v63, v63
    v_pk_fma_f32 v[40:41], v[40:41], v[56:57], v[88:89]
    v_pk_fma_f32 v[42:43], v[42:43], v[58:59], v[90:91]
    v_pk_fma_f32 v[44:45], v[44:45], v[60:61], v[92:93]
    v_pk_fma_f32 v[46:47], v[46:47], v[62:63], v[94:95]
    v_cvt_pk_bf16_f32 v68, v40, v41
    v_cvt_pk_bf16_f32 v69, v42, v43
    v_cvt_pk_bf16_f32 v70, v44, v45
    v_cvt_pk_bf16_f32 v71, v46, v47
    buffer_store_dwordx4 v[68:71], v31, s[44:47], s51 offen offset:64
    s_endpgm
L_kgen:
    s_and_b32 s66, s3, 1
    s_bfe_u32 s48, s3, 0x10001
    v_and_b32 v125, 31, v0
    v_lshrrev_b32 v117, 5, v0
    v_bfe_u32 v118, v0, 2, 2
    v_lshl_add_u32 v118, v117, 3, v118
    v_lshlrev_b32 v116, 7, v118
    v_bfe_u32 v118, v0, 3, 1
    v_lshl_add_u32 v116, v118, 6, v116
    v_bfe_u32 v118, v0, 4, 1
    v_lshl_add_u32 v116, v118, 5, v116
    v_and_b32 v118, 3, v0
    v_lshl_add_u32 v116, v118, 3, v116
    s_mul_i32 s101, s48, 20480
    v_add_u32 v116, s101, v116
    v_xor_b32 v117, 64, v116
    v_add_u32 v118, 81920, v116
    v_add_u32 v119, 81920, v117
    s_lshl_b32 s67, s48, 2
    v_add_u32 v120, s67, v15
    v_lshlrev_b32 v121, 4, v0
    s_and_b32 s67, s3, 3
    s_lshl_b32 s67, s67, 2
    v_add_u32 v122, s67, v15
    v_xor_b32 v123, 4, v122
    s_lshl_b32 s67, s66, 13
    s_add_u32 s101, s101, s67
    s_add_u32 s101, s101, 40960
    v_add_u32 v124, s101, v121
    v_min_u32 v125, 28, v125
    v_lshlrev_b32 v125, 2, v125
    v_add_u32 v126, 4096, v125
    v_and_b32 v127, 1, v0
    s_lshl_b32 s67, s66, 3
    v_lshl_add_u32 v127, v127, 2, s67
    v_add_u32 v127, v127, v15
    v_mov_b32 v114, 1
    v_mov_b32 v115, 2
    s_lshl_b32 s101, s33, 1
    s_add_u32 s101, s101, s66
    s_mul_i32 s101, s101, 88064
    s_mul_i32 s67, s48, 44032
    s_add_u32 s101, s101, s67
    s_add_u32 s101, s101, 6356992
    s_lshl_b32 s48, s33, 7
    s_add_u32 s48, s48, 12288
    s_mul_i32 s58, s54, 17408
    s_add_u32 s58, s58, 122880
    v_mov_b32 v24, 0x3f803f80
    v_mov_b32 v25, 0x00003f80
    v_mov_b32 v26, 0x3f800000
    s_mov_b32 s60, 0x3b000000
    s_mov_b32 s59, 0x3727c5ac
    v_mul_u32_u24 v4, 144, v0
    s_lshl_b32 s57, s54, 3
    s_add_u32 s57, s57, 81920
    v_add_u32 v4, s57, v4
    v_lshrrev_b32 v5, 3, v0
    v_mul_u32_u24 v5, 144, v5
    v_and_b32 v6, 7, v0
    v_lshl_add_u32 v5, v6, 4, v5
    s_mul_i32 s57, s54, 4608
    s_add_u32 s57, s57, 81920
    v_add_u32 v5, s57, v5
    s_lshl_b32 s57, s54, 2
    v_add_u32 v21, s57, v15
    v_mov_b32 v22, 1
    v_lshlrev_b32 v3, 3, v0
    v_lshrrev_b32 v6, 1, v0
    s_waitcnt vmcnt(5)
    v_dot2_f32_bf16 v160, v128, v24, 0
    v_dot2_f32_bf16 v164, v128, v128, 0
    v_dot2_f32_bf16 v160, v129, v24, v160
    v_dot2_f32_bf16 v164, v129, v129, v164
    v_dot2_f32_bf16 v160, v130, v24, v160
    v_dot2_f32_bf16 v164, v130, v130, v164
    v_dot2_f32_bf16 v160, v131, v24, v160
    v_dot2_f32_bf16 v164, v131, v131, v164
    s_waitcnt vmcnt(4)
    v_dot2_f32_bf16 v161, v132, v24, 0
    v_dot2_f32_bf16 v165, v132, v132, 0
    v_dot2_f32_bf16 v161, v133, v24, v161
    v_dot2_f32_bf16 v165, v133, v133, v165
    v_dot2_f32_bf16 v161, v134, v24, v161
    v_dot2_f32_bf16 v165, v134, v134, v165
    v_dot2_f32_bf16 v161, v135, v24, v161
    v_dot2_f32_bf16 v165, v135, v135, v165
    s_waitcnt vmcnt(3)
    v_dot2_f32_bf16 v162, v136, v24, 0
    v_dot2_f32_bf16 v166, v136, v136, 0
    v_dot2_f32_bf16 v162, v137, v24, v162
    v_dot2_f32_bf16 v166, v137, v137, v166
    v_dot2_f32_bf16 v162, v138, v24, v162
    v_dot2_f32_bf16 v166, v138, v138, v166
    v_dot2_f32_bf16 v162, v139, v24, v162
    v_dot2_f32_bf16 v166, v139, v139, v166
    s_waitcnt vmcnt(2)
    v_dot2_f32_bf16 v163, v140, v24, 0
    v_dot2_f32_bf16 v167, v140, v140, 0
    v_dot2_f32_bf16 v163, v141, v24, v163
    v_dot2_f32_bf16 v167, v141, v141, v167
    v_dot2_f32_bf16 v163, v142, v24, v163
    v_dot2_f32_bf16 v167, v142, v142, v167
    v_dot2_f32_bf16 v163, v143, v24, v163
    v_dot2_f32_bf16 v167, v143, v143, v167
    v_permlane32_swap_b32 v160, v162
    s_nop 0
    v_permlane32_swap_b32 v161, v163
    v_permlane32_swap_b32 v164, v166
    v_permlane32_swap_b32 v165, v167
    v_add_f32 v160, v160, v162
    v_add_f32 v161, v161, v163
    v_add_f32 v164, v164, v166
    v_add_f32 v165, v165, v167
    v_permlane16_swap_b32 v160, v161
    s_nop 0
    v_permlane16_swap_b32 v164, v165
    v_add_f32 v160, v160, v161
    v_add_f32 v164, v164, v165
    s_nop 0
    v_add_f32_dpp v160, v160, v160 row_ror:8 row_mask:0xf bank_mask:0xf
    v_add_f32_dpp v164, v164, v164 row_ror:8 row_mask:0xf bank_mask:0xf
    s_nop 0
    v_add_f32_dpp v160, v160, v160 row_ror:4 row_mask:0xf bank_mask:0xf
    v_add_f32_dpp v164, v164, v164 row_ror:4 row_mask:0xf bank_mask:0xf
    s_nop 0
    v_add_f32_dpp v160, v160, v160 row_ror:2 row_mask:0xf bank_mask:0xf
    v_add_f32_dpp v164, v164, v164 row_ror:2 row_mask:0xf bank_mask:0xf
    s_nop 0
    v_add_f32_dpp v160, v160, v160 row_ror:1 row_mask:0xf bank_mask:0xf
    v_add_f32_dpp v164, v164, v164 row_ror:1 row_mask:0xf bank_mask:0xf
    v_mul_f32 v160, s60, v160
    v_mul_f32 v164, s60, v164
    v_fma_f32 v164, -v160, v160, v164
    v_max_f32 v164, 0, v164
    v_cvt_pk_bf16_f32 v161, v164, -v160
    v_and_b32 v160, 0xffff0000, v161
    v_lshlrev_b32 v164, 16, v161
    v_add_f32 v164, s59, v164
    v_cvt_pk_bf16_f32 v164, v164, v164
    v_and_b32 v164, 0xffff0000, v164
    v_sqrt_f32 v164, v164
    v_readlane_b32 s8, v160, 0
    v_readlane_b32 s9, v160, 16
    v_readlane_b32 s10, v160, 32
    v_readlane_b32 s11, v160, 48
    v_cvt_pk_bf16_f32 v112, v164, v160
    v_lshlrev_b32 v164, 16, v112
    v_rcp_f32 v164, v164
    v_dot2_f32_bf16 v168, v128, v25, s8
    v_dot2_f32_bf16 v169, v132, v25, s9
    v_dot2_f32_bf16 v170, v136, v25, s10
    v_dot2_f32_bf16 v171, v140, v25, s11
    v_readlane_b32 s12, v164, 0
    v_readlane_b32 s13, v164, 16
    v_readlane_b32 s14, v164, 32
    v_readlane_b32 s15, v164, 48
    v_dot2_f32_bf16 v172, v128, v26, s8
    v_dot2_f32_bf16 v173, v132, v26, s9
    v_dot2_f32_bf16 v174, v136, v26, s10
    v_dot2_f32_bf16 v175, v140, v26, s11
    v_dot2_f32_bf16 v176, v129, v25, s8
    v_dot2_f32_bf16 v177, v133, v25, s9
    v_dot2_f32_bf16 v178, v137, v25, s10
    v_dot2_f32_bf16 v179, v141, v25, s11
    v_dot2_f32_bf16 v180, v129, v26, s8
    v_dot2_f32_bf16 v181, v133, v26, s9
    v_dot2_f32_bf16 v182, v137, v26, s10
    v_dot2_f32_bf16 v183, v141, v26, s11
    v_dot2_f32_bf16 v184, v130, v25, s8
    v_dot2_f32_bf16 v185, v134, v25, s9
    v_dot2_f32_bf16 v186, v138, v25, s10
    v_dot2_f32_bf16 v187, v142, v25, s11
    v_dot2_f32_bf16 v188, v130, v26, s8
    v_dot2_f32_bf16 v189, v134, v26, s9
    v_dot2_f32_bf16 v190, v138, v26, s10
    v_dot2_f32_bf16 v191, v142, v26, s11
    v_dot2_f32_bf16 v192, v131, v25, s8
    v_dot2_f32_bf16 v193, v135, v25, s9
    v_dot2_f32_bf16 v194, v139, v25, s10
    v_dot2_f32_bf16 v195, v143, v25, s11
    v_dot2_f32_bf16 v196, v131, v26, s8
    v_dot2_f32_bf16 v197, v135, v26, s9
    v_dot2_f32_bf16 v198, v139, v26, s10
    v_dot2_f32_bf16 v199, v143, v26, s11
    v_pk_mul_f32 v[168:169], v[168:169], s[12:13]
    v_pk_mul_f32 v[170:171], v[170:171], s[14:15]
    v_pk_mul_f32 v[172:173], v[172:173], s[12:13]
    v_pk_mul_f32 v[174:175], v[174:175], s[14:15]
    v_pk_mul_f32 v[176:177], v[176:177], s[12:13]
    v_pk_mul_f32 v[178:179], v[178:179], s[14:15]
    v_pk_mul_f32 v[180:181], v[180:181], s[12:13]
    v_pk_mul_f32 v[182:183], v[182:183], s[14:15]
    v_pk_mul_f32 v[184:185], v[184:185], s[12:13]
    v_pk_mul_f32 v[186:187], v[186:187], s[14:15]
    v_pk_mul_f32 v[188:189], v[188:189], s[12:13]
    v_pk_mul_f32 v[190:191], v[190:191], s[14:15]
    v_pk_mul_f32 v[192:193], v[192:193], s[12:13]
    v_pk_mul_f32 v[194:195], v[194:195], s[14:15]
    v_pk_mul_f32 v[196:197], v[196:197], s[12:13]
    v_pk_mul_f32 v[198:199], v[198:199], s[14:15]
    v_cvt_pk_bf16_f32 v144, v168, v169
    v_cvt_pk_bf16_f32 v145, v170, v171
    ds_write_b64 v4, v[144:145] offset:0
    v_cvt_pk_bf16_f32 v146, v172, v173
    v_cvt_pk_bf16_f32 v147, v174, v175
    ds_write_b64 v4, v[146:147] offset:16
    v_cvt_pk_bf16_f32 v148, v176, v177
    v_cvt_pk_bf16_f32 v149, v178, v179
    ds_write_b64 v4, v[148:149] offset:32
    v_cvt_pk_bf16_f32 v150, v180, v181
    v_cvt_pk_bf16_f32 v151, v182, v183
    ds_write_b64 v4, v[150:151] offset:48
    v_cvt_pk_bf16_f32 v152, v184, v185
    v_cvt_pk_bf16_f32 v153, v186, v187
    ds_write_b64 v4, v[152:153] offset:64
    v_cvt_pk_bf16_f32 v154, v188, v189
    v_cvt_pk_bf16_f32 v155, v190, v191
    ds_write_b64 v4, v[154:155] offset:80
    v_cvt_pk_bf16_f32 v156, v192, v193
    v_cvt_pk_bf16_f32 v157, v194, v195
    ds_write_b64 v4, v[156:157] offset:96
    v_cvt_pk_bf16_f32 v158, v196, v197
    v_cvt_pk_bf16_f32 v159, v198, v199
    ds_write_b64 v4, v[158:159] offset:112
    s_waitcnt vmcnt(0)
    v_readfirstlane_b32 s52, v14
    s_nop 0
    s_mul_i32 s52, s52, 0x9E3779B1
    s_add_u32 s52, s52, 0x7F4A7C15
    v_mov_b32 v17, s52
    s_or_b32 s52, s52, 0x10000
    v_mov_b32 v16, s52
    s_cmp_lg_u32 s54, 0
    s_cbranch_scc1 L_k_nn
    ds_write_b64 v15, v[16:17] offset:32
L_k_nn:
    s_waitcnt lgkmcnt(0)
    ds_write_b32 v21, v22 offset:48
Lw34:
    ds_read_b64 v[16:17], v15 offset:48
    s_waitcnt lgkmcnt(0)
    v_min_u32 v16, v16, v17
    s_nop 0
    v_readfirstlane_b32 s67, v16
    s_nop 0
    s_cmp_lg_u32 s67, 0
    s_cbranch_scc1 Lw34d
    s_sub_u32 s55, s55, 1
    s_max_i32 s55, s55, 0
    s_cmp_lg_u32 s55, 0
    s_cbranch_scc1 Lw34
Lw34d:
    ds_read_b128 v[96:99], v5 offset:0
    ds_read_b128 v[100:103], v5 offset:1152
    ds_read_b128 v[104:107], v5 offset:2304
    ds_read_b128 v[108:111], v5 offset:3456
Lw35:
    ds_read_b32 v16, v15 offset:32
    s_waitcnt lgkmcnt(0)
    v_readfirstlane_b32 s67, v16
    s_nop 0
    s_cmp_lg_u32 s67, 0
    s_cbranch_scc1 Lw35d
    s_sub_u32 s55, s55, 1
    s_max_i32 s55, s55, 0
    s_cmp_lg_u32 s55, 0
    s_cbranch_scc1 Lw35
Lw35d:
    s_mov_b32 s52, s67
    ds_write_b32 v21, v22 offset:128
    v_mov_b32 v113, s52
    s_lshr_b32 s47, s46, 7
    s_add_u32 s47, s47, 32768
    s_mul_i32 s57, s53, 384
    s_add_u32 s46, s46, s57
    s_add_u32 s46, s46, 2097664
    s_lshl_b32 s57, s54, 3
    v_add_u32 v7, s57, v15
    v_add_u32 v14, s58, v2
Lw36:
    ds_read_b64 v[16:17], v7 offset:144
    s_waitcnt lgkmcnt(0)
    v_min_u32 v16, v16, v17
    s_nop 0
    v_readfirstlane_b32 s67, v16
    s_nop 0
    s_cmp_lg_u32 s67, 0
    s_cbranch_scc1 Lw36d
    s_sleep 1
    s_sub_u32 s55, s55, 1
    s_max_i32 s55, s55, 0
    s_cmp_lg_u32 s55, 0
    s_cbranch_scc1 Lw36
Lw36d:
    ds_read_b128 v[32:35], v14 offset:0
    ds_read_b128 v[36:39], v14 offset:1024
    ds_read_b128 v[40:43], v14 offset:2048
    ds_read_b128 v[44:47], v14 offset:3072
    ds_read_b128 v[64:67], v14 offset:8704
    ds_read_b128 v[68:71], v14 offset:9728
    ds_read_b128 v[72:75], v14 offset:10752
    ds_read_b128 v[76:79], v14 offset:11776
    s_waitcnt lgkmcnt(0)
    v_add_f32 v32, v32, v64
    v_add_f32 v33, v33, v65
    v_add_f32 v34, v34, v66
    v_add_f32 v35, v35, v67
    v_add_f32 v36, v36, v68
    v_add_f32 v37, v37, v69
    v_add_f32 v38, v38, v70
    v_add_f32 v39, v39, v71
    v_add_f32 v40, v40, v72
    v_add_f32 v41, v41, v73
    v_add_f32 v42, v42, v74
    v_add_f32 v43, v43, v75
    v_add_f32 v44, v44, v76
    v_add_f32 v45, v45, v77
    v_add_f32 v46, v46, v78
    v_add_f32 v47, v47, v79
    ds_write_b32 v21, v22 offset:64
    v_lshlrev_b32 v9, 16, v9
    v_cmp_eq_u32 vcc, 0, v0
    s_nop 1
    v_cndmask_b32 v9, 0, v9, vcc
    v_sub_u32 v12, 1008, v2
    v_add_u32 v12, s58, v12
    v_and_b32 v13, 1, v0
    v_cmp_eq_u32 vcc, 1, v13
    v_mov_b32 v16, 0
    v_mov_b32 v17, 0
    v_mov_b32 v18, 0
    v_mov_b32 v19, 0
    v_add_f32 v32, v32, v9
    v_cvt_pk_bf16_f32 v48, v39, v38
    v_cvt_pk_bf16_f32 v49, v37, v36
    v_cvt_pk_bf16_f32 v50, v35, v34
    v_cvt_pk_bf16_f32 v51, v33, v32
    v_cvt_pk_bf16_f32 v52, v40, v39
    v_cvt_pk_bf16_f32 v53, v38, v37
    v_cvt_pk_bf16_f32 v54, v36, v35
    v_cvt_pk_bf16_f32 v55, v34, v33
    ds_write_b128 v12, v[48:51] offset:3072
    ds_write_b128 v12, v[52:55] offset:7232
    v_cvt_pk_bf16_f32 v56, v43, v43
    v_cvt_pk_bf16_f32 v57, v42, v42
    v_cvt_pk_bf16_f32 v58, v42, v41
    v_cvt_pk_bf16_f32 v59, v41, v41
    v_cvt_pk_bf16_f32 v60, v43, v43
    v_cvt_pk_bf16_f32 v61, v43, v42
    v_cvt_pk_bf16_f32 v62, v42, v42
    v_cvt_pk_bf16_f32 v63, v41, v41
    ds_write_b128 v12, v[56:59] offset:2048
    ds_write_b128 v12, v[60:63] offset:6208
    v_cndmask_b32 v20, v44, v45, vcc
    v_cvt_pk_bf16_f32 v48, v45, v45
    v_cvt_pk_bf16_f32 v49, v45, v20
    v_cvt_pk_bf16_f32 v50, v44, v44
    v_cvt_pk_bf16_f32 v51, v44, v44
    v_cvt_pk_bf16_f32 v52, v45, v45
    v_cvt_pk_bf16_f32 v53, v45, v45
    v_cvt_pk_bf16_f32 v54, v20, v44
    v_cvt_pk_bf16_f32 v55, v44, v44
    ds_write_b128 v12, v[48:51] offset:1024
    ds_write_b128 v12, v[52:55] offset:5184
    v_cndmask_b32 v20, v46, v47, vcc
    v_cvt_pk_bf16_f32 v56, v47, v47
    v_cvt_pk_bf16_f32 v57, v47, v20
    v_cvt_pk_bf16_f32 v58, v46, v46
    v_cvt_pk_bf16_f32 v59, v46, v46
    v_cvt_pk_bf16_f32 v60, v47, v47
    v_cvt_pk_bf16_f32 v61, v47, v47
    v_cvt_pk_bf16_f32 v62, v20, v46
    v_cvt_pk_bf16_f32 v63, v46, v46
    ds_write_b128 v12, v[56:59] offset:0
    ds_write_b128 v12, v[60:63] offset:4160
    s_mov_b64 exec, 0xf
    ds_write_b128 v14, v[16:19] offset:4096
    s_mov_b32 exec_lo, -1
    ds_write_b128 v14, v[16:19] offset:8320
    s_mov_b64 exec, 1
    v_cvt_pk_bf16_f32 v16, v32, 0
    s_mov_b64 exec, 0xf
    ds_write_b128 v14, v[16:19] offset:8256
    s_mov_b64 exec, -1
Lw37:
    ds_read_b64 v[16:17], v15 offset:0
    s_waitcnt lgkmcnt(0)
    v_min_u32 v16, v16, v17
    s_nop 0
    v_readfirstlane_b32 s67, v16
    s_nop 0
    s_cmp_ge_u32 s67, 2
    s_cbranch_scc1 Lw37d
    s_sleep 4
    s_sub_u32 s55, s55, 1
    s_max_i32 s55, s55, 0
    s_cmp_lg_u32 s55, 0
    s_cbranch_scc1 Lw37
Lw37d:
    buffer_store_dwordx4 v[96:99], v2, s[40:43], s46 offen offset:0 sc1
    buffer_store_dwordx4 v[100:103], v2, s[40:43], s46 offen offset:1024 sc1
    buffer_store_dwordx4 v[104:107], v2, s[40:43], s46 offen offset:2048 sc1
    buffer_store_dwordx4 v[108:111], v2, s[40:43], s46 offen offset:3072 sc1
    s_mov_b32 exec_lo, 0x00010001
    s_mov_b32 exec_hi, 0x00010001
    buffer_store_dwordx2 v[112:113], v6, s[40:43], s47 offen sc1
    s_mov_b64 exec, -1
    s_lshl_b32 s57, s54, 8
    s_add_u32 s57, s57, s53
    s_lshl_b32 s57, s57, 2
    s_add_u32 s57, s57, 8192
    s_waitcnt vmcnt(0)
    s_mov_b64 exec, 1
    buffer_store_dword v113, v2, s[40:43], s57 offen sc1
    s_mov_b64 exec, -1
    s_cmp_eq_u32 s32, 1
    s_cbranch_scc1 L_k_ed
    s_lshl_b32 s61, s6, 10
    s_add_u32 s61, s61, 32768
    s_mul_i32 s62, s7, 1536
    s_add_u32 s62, s62, 49152
    s_cmp_eq_u32 s54, 0
    s_cselect_b32 s61, s61, s62
    s_cselect_b32 s62, 0, 1024
    s_add_u32 s62, s62, s61
    s_lshl_b32 s63, s54, 9
    s_add_u32 s63, s63, 157952
    v_lshl_add_u32 v4, v0, 2, s63
    s_cmp_eq_u32 s54, 0
    s_cselect_b32 s57, 7, 7
Lw38:
    ds_read_b64 v[16:17], v15 offset:0
    s_waitcnt lgkmcnt(0)
    v_min_u32 v16, v16, v17
    s_nop 0
    v_readfirstlane_b32 s67, v16
    s_nop 0
    s_cmp_ge_u32 s67, s57
    s_cbranch_scc1 Lw38d
    s_sleep 4
    s_sub_u32 s55, s55, 1
    s_max_i32 s55, s55, 0
    s_cmp_lg_u32 s55, 0
    s_cbranch_scc1 Lw38
Lw38d:
L_k_el:
    buffer_load_dwordx2 v[96:97], v3, s[40:43], s61 offen sc1
    buffer_load_dwordx2 v[98:99], v3, s[40:43], s61 offen offset:512 sc1
    buffer_load_dwordx2 v[100:101], v3, s[40:43], s62 offen sc1
    s_waitcnt vmcnt(0)
    v_xor_b32 v16, s52, v97
    v_xor_b32 v17, s52, v99
    v_xor_b32 v18, s52, v101
    v_or3_b32 v16, v16, v17, v18
    v_cmp_ne_u32 vcc, 0, v16
    s_nop 0
    s_cbranch_vccz L_k_eo
    s_sleep 8
    s_sub_u32 s55, s55, 1
    s_max_i32 s55, s55, 0
    s_cmp_lg_u32 s55, 0
    s_cbranch_scc1 L_k_el
L_k_eo:
    ds_write_b32 v4, v96
    ds_write_b32 v4, v98 offset:256
    s_cmp_eq_u32 s54, 0
    s_cbranch_scc1 L_k_e2
    ds_write_b32 v4, v100 offset:512
L_k_e2:
    s_waitcnt lgkmcnt(0)
    ds_write_b32 v21, v22 offset:136
L_k_ed:
    s_lshr_b32 s61, s53, 7
    s_lshl_b32 s61, s61, 10
    s_lshl_b32 s62, s54, 9
    s_add_u32 s61, s61, s62
    s_add_u32 s61, s61, 8192
    v_lshrrev_b32 v4, 1, v0
    v_mul_u32_u24 v5, 8576, v4
    v_lshl_add_u32 v5, v13, 4, v5
    v_mul_u32_u24 v6, 17408, v13
    v_lshl_add_u32 v6, v4, 4, v6
    s_lshl_b32 s62, s54, 11
    s_add_u32 s62, s62, 131712
    v_add_u32 v6, s62, v6
    s_mul_i32 s62, s54, 1097728
    s_lshl_b32 s63, s53, 5
    s_add_u32 s62, s62, s63
    s_add_u32 s62, s62, 2097664
Lw39:
    ds_read_b64 v[16:17], v15 offset:0
    s_waitcnt lgkmcnt(0)
    v_min_u32 v16, v16, v17
    s_nop 0
    v_readfirstlane_b32 s67, v16
    s_nop 0
    s_cmp_ge_u32 s67, 8
    s_cbranch_scc1 Lw39d
    s_sleep 4
    s_sub_u32 s55, s55, 1
    s_max_i32 s55, s55, 0
    s_cmp_lg_u32 s55, 0
    s_cbranch_scc1 Lw39
Lw39d:
L_k_fl:
    buffer_load_dwordx2 v[16:17], v3, s[40:43], s61 offen sc1
    s_waitcnt vmcnt(0)
    v_xor_b32 v16, s52, v16
    v_xor_b32 v17, s52, v17
    v_or_b32 v16, v16, v17
    v_cmp_ne_u32 vcc, 0, v16
    s_nop 0
    s_cbranch_vccz L_k_fld
    s_sleep 16
    s_sub_u32 s55, s55, 1
    s_max_i32 s55, s55, 0
    s_cmp_lg_u32 s55, 0
    s_cbranch_scc1 L_k_fl
L_k_fld:
    s_add_u32 s63, s62, 0
    buffer_load_dwordx4 v[96:99], v5, s[40:43], s63 offen sc1
    s_add_u32 s63, s62, 274432
    buffer_load_dwordx4 v[100:103], v5, s[40:43], s63 offen sc1
    s_add_u32 s63, s62, 548864
    buffer_load_dwordx4 v[104:107], v5, s[40:43], s63 offen sc1
    s_add_u32 s63, s62, 823296
    buffer_load_dwordx4 v[108:111], v5, s[40:43], s63 offen sc1
Lw40:
    ds_read_b64 v[16:17], v15 offset:64
    s_waitcnt lgkmcnt(0)
    v_min_u32 v16, v16, v17
    s_nop 0
    v_readfirstlane_b32 s67, v16
    s_nop 0
    s_cmp_lg_u32 s67, 0
    s_cbranch_scc1 Lw40d
    s_sub_u32 s55, s55, 1
    s_max_i32 s55, s55, 0
    s_cmp_lg_u32 s55, 0
    s_cbranch_scc1 Lw40
Lw40d:
    s_waitcnt vmcnt(3)
    ds_write_b128 v6, v[96:99] offset:0
    s_waitcnt vmcnt(2)
    ds_write_b128 v6, v[100:103] offset:512
    s_waitcnt vmcnt(1)
    ds_write_b128 v6, v[104:107] offset:1024
    s_waitcnt vmcnt(0)
    ds_write_b128 v6, v[108:111] offset:1536
    s_waitcnt lgkmcnt(0)
    ds_write_b32 v21, v22 offset:72
    s_cmp_lg_u32 s56, 0
    s_cbranch_scc1 L_k_nb
Lw41:
    ds_read_b64 v[16:17], v15 offset:72
    s_waitcnt lgkmcnt(0)
    v_min_u32 v16, v16, v17
    s_nop 0
    v_readfirstlane_b32 s67, v16
    s_nop 0
    s_cmp_lg_u32 s67, 0
    s_cbranch_scc1 Lw41d
    s_sub_u32 s55, s55, 1
    s_max_i32 s55, s55, 0
    s_cmp_lg_u32 s55, 0
    s_cbranch_scc1 Lw41
Lw41d:
    ds_read_b32 v4, v15 offset:36
    v_mov_b32 v5, 0
    s_waitcnt lgkmcnt(0)
    s_mov_b64 exec, 1
    buffer_store_dword v4, v5, s[40:43], 0 offen sc1
    s_mov_b64 exec, -1
L_k_nb:
L_g2:
    s_setprio 3
Lv42:
    ds_read_b32 v16, v120 offset:0
    s_waitcnt lgkmcnt(0)
    v_cmp_gt_u32 vcc, 10, v16
    s_nop 0
    s_cbranch_vccz Lv42d
    s_sleep 2
    s_sub_u32 s55, s55, 1
    s_max_i32 s55, s55, 0
    s_cmp_lg_u32 s55, 0
    s_cbranch_scc1 Lv42
Lv42d:
    ds_read_b64_tr_b16 v[32:33], v118 offset:0
    ds_read_b64_tr_b16 v[34:35], v118 offset:512
    ds_read_b64_tr_b16 v[36:37], v119 offset:0
    ds_read_b64_tr_b16 v[38:39], v119 offset:512
    ds_read_b64_tr_b16 v[40:41], v118 offset:2048
    ds_read_b64_tr_b16 v[42:43], v118 offset:2560
    ds_read_b64_tr_b16 v[44:45], v119 offset:2048
    ds_read_b64_tr_b16 v[46:47], v119 offset:2560
    ds_read_b64_tr_b16 v[48:49], v118 offset:4096
    ds_read_b64_tr_b16 v[50:51], v118 offset:4608
    ds_read_b64_tr_b16 v[52:53], v119 offset:4096
    ds_read_b64_tr_b16 v[54:55], v119 offset:4608
    ds_read_b64_tr_b16 v[56:57], v118 offset:6144
    ds_read_b64_tr_b16 v[58:59], v118 offset:6656
    ds_read_b64_tr_b16 v[60:61], v119 offset:6144
    ds_read_b64_tr_b16 v[62:63], v119 offset:6656
    ds_read_b64_tr_b16 v[64:65], v118 offset:8192
    ds_read_b64_tr_b16 v[66:67], v118 offset:8704
    ds_read_b64_tr_b16 v[68:69], v119 offset:8192
    ds_read_b64_tr_b16 v[70:71], v119 offset:8704
    ds_read_b64_tr_b16 v[72:73], v118 offset:10240
    ds_read_b64_tr_b16 v[74:75], v118 offset:10752
    ds_read_b64_tr_b16 v[76:77], v119 offset:10240
    ds_read_b64_tr_b16 v[78:79], v119 offset:10752
    ds_read_b64_tr_b16 v[80:81], v118 offset:12288
    ds_read_b64_tr_b16 v[82:83], v118 offset:12800
    ds_read_b64_tr_b16 v[84:85], v119 offset:12288
    ds_read_b64_tr_b16 v[86:87], v119 offset:12800
    ds_read_b64_tr_b16 v[88:89], v118 offset:14336
    ds_read_b64_tr_b16 v[90:91], v118 offset:14848
    ds_read_b64_tr_b16 v[92:93], v119 offset:14336
    ds_read_b64_tr_b16 v[94:95], v119 offset:14848
    ds_read_b64_tr_b16 v[96:97], v118 offset:16384
    ds_read_b64_tr_b16 v[98:99], v118 offset:16896
    ds_read_b64_tr_b16 v[100:101], v119 offset:16384
    ds_read_b64_tr_b16 v[102:103], v119 offset:16896
    ds_read_b64_tr_b16 v[104:105], v118 offset:18432
    ds_read_b64_tr_b16 v[106:107], v118 offset:18944
    ds_read_b64_tr_b16 v[108:109], v119 offset:18432
    ds_read_b64_tr_b16 v[110:111], v119 offset:18944
    ds_read_b64_tr_b16 v[128:129], v116 offset:0
    ds_read_b64_tr_b16 v[130:131], v116 offset:512
    ds_read_b64_tr_b16 v[132:133], v117 offset:0
    ds_read_b64_tr_b16 v[134:135], v117 offset:512
    ds_read_b64_tr_b16 v[136:137], v116 offset:2048
    ds_read_b64_tr_b16 v[138:139], v116 offset:2560
    ds_read_b64_tr_b16 v[140:141], v117 offset:2048
    ds_read_b64_tr_b16 v[142:143], v117 offset:2560
    ds_read_b64_tr_b16 v[144:145], v116 offset:4096
    ds_read_b64_tr_b16 v[146:147], v116 offset:4608
    ds_read_b64_tr_b16 v[148:149], v117 offset:4096
    ds_read_b64_tr_b16 v[150:151], v117 offset:4608
    s_waitcnt lgkmcnt(0)
    ds_write_b32 v122, v114 offset:160
    s_cmp_lt_u32 s3, 6
    s_cbranch_scc1 L_g2_nl
Lv43:
    ds_read_b32 v16, v127 offset:160
    s_waitcnt lgkmcnt(0)
    v_cmp_gt_u32 vcc, 1, v16
    s_nop 0
    s_cbranch_vccz Lv43d
    s_sleep 1
    s_sub_u32 s55, s55, 1
    s_max_i32 s55, s55, 0
    s_cmp_lg_u32 s55, 0
    s_cbranch_scc1 Lv43
Lv43d:
    s_cmp_eq_u32 s32, 1
    s_cbranch_scc1 L_g2_np
Lv44:
    ds_read_b32 v18, v11 offset:208
    s_waitcnt lgkmcnt(0)
    v_cmp_gt_u32 vcc, 1, v18
    s_nop 0
    s_cbranch_vccz Lv44d
    s_sleep 2
    s_sub_u32 s55, s55, 1
    s_max_i32 s55, s55, 0
    s_cmp_lg_u32 s55, 0
    s_cbranch_scc1 Lv44
Lv44d:
L_g2_np:
    s_add_u32 s65, s59, 81920
    s_add_u32 m0, s65, 0
    s_add_u32 s56, s57, 0
    buffer_load_dwordx4 v8, s[20:23], s56 offen lds
    s_add_u32 m0, s65, 1024
    s_add_u32 s56, s57, 8192
    buffer_load_dwordx4 v8, s[20:23], s56 offen lds
    s_add_u32 m0, s65, 2048
    s_add_u32 s56, s57, 16384
    buffer_load_dwordx4 v8, s[20:23], s56 offen lds
    s_add_u32 m0, s65, 3072
    s_add_u32 s56, s57, 24576
    buffer_load_dwordx4 v8, s[20:23], s56 offen lds
    s_add_u32 m0, s65, 4096
    s_add_u32 s56, s57, 32768
    buffer_load_dwordx4 v8, s[20:23], s56 offen lds
    s_add_u32 m0, s65, 5120
    s_add_u32 s56, s57, 40960
    buffer_load_dwordx4 v8, s[20:23], s56 offen lds
    s_add_u32 m0, s65, 6144
    s_add_u32 s56, s57, 49152
    buffer_load_dwordx4 v8, s[20:23], s56 offen lds
    s_add_u32 m0, s65, 7168
    s_add_u32 s56, s57, 57344
    buffer_load_dwordx4 v8, s[20:23], s56 offen lds
    s_add_u32 m0, s65, 8192
    s_add_u32 s56, s57, 65536
    buffer_load_dwordx4 v8, s[20:23], s56 offen lds
    s_add_u32 m0, s65, 9216
    s_add_u32 s56, s57, 73728
    buffer_load_dwordx4 v8, s[20:23], s56 offen lds
    s_add_u32 m0, s65, 10240
    s_add_u32 s56, s57, 81920
    buffer_load_dwordx4 v8, s[20:23], s56 offen lds
    s_add_u32 m0, s65, 11264
    s_add_u32 s56, s57, 90112
    buffer_load_dwordx4 v8, s[20:23], s56 offen lds
    s_add_u32 m0, s65, 12288
    s_add_u32 s56, s57, 98304
    buffer_load_dwordx4 v8, s[20:23], s56 offen lds
    s_add_u32 m0, s65, 13312
    s_add_u32 s56, s57, 106496
    buffer_load_dwordx4 v8, s[20:23], s56 offen lds
    s_add_u32 m0, s65, 14336
    s_add_u32 s56, s57, 114688
    buffer_load_dwordx4 v8, s[20:23], s56 offen lds
    s_add_u32 m0, s65, 15360
    s_add_u32 s56, s57, 122880
    buffer_load_dwordx4 v8, s[20:23], s56 offen lds
    s_add_u32 m0, s65, 16384
    s_add_u32 s56, s57, 131072
    buffer_load_dwordx4 v8, s[20:23], s56 offen lds
    s_add_u32 m0, s65, 17408
    s_add_u32 s56, s57, 139264
    buffer_load_dwordx4 v8, s[20:23], s56 offen lds
    s_add_u32 m0, s65, 18432
    s_add_u32 s56, s57, 147456
    buffer_load_dwordx4 v8, s[20:23], s56 offen lds
    s_add_u32 m0, s65, 19456
    s_add_u32 s56, s57, 155648
    buffer_load_dwordx4 v8, s[20:23], s56 offen lds
    s_mov_b32 s65, s59
    s_add_u32 s57, s57, 163840
    s_add_u32 m0, s65, 0
    s_add_u32 s56, s57, 0
    buffer_load_dwordx4 v8, s[20:23], s56 offen lds
    s_add_u32 m0, s65, 1024
    s_add_u32 s56, s57, 8192
    buffer_load_dwordx4 v8, s[20:23], s56 offen lds
    s_add_u32 m0, s65, 2048
    s_add_u32 s56, s57, 16384
    buffer_load_dwordx4 v8, s[20:23], s56 offen lds
    s_add_u32 m0, s65, 3072
    s_add_u32 s56, s57, 24576
    buffer_load_dwordx4 v8, s[20:23], s56 offen lds
    s_add_u32 m0, s65, 4096
    s_add_u32 s56, s57, 32768
    buffer_load_dwordx4 v8, s[20:23], s56 offen lds
    s_add_u32 m0, s65, 5120
    s_add_u32 s56, s57, 40960
    buffer_load_dwordx4 v8, s[20:23], s56 offen lds
Lw45:
    ds_read_b32 v16, v15 offset:32
    s_waitcnt lgkmcnt(0)
    v_readfirstlane_b32 s67, v16
    s_nop 0
    s_cmp_lg_u32 s67, 0
    s_cbranch_scc1 Lw45d
    s_sub_u32 s55, s55, 1
    s_max_i32 s55, s55, 0
    s_cmp_lg_u32 s55, 0
    s_cbranch_scc1 Lw45
Lw45d:
    s_mov_b32 s52, s67
    v_mov_b32 v10, 13
    s_waitcnt vmcnt(0)
    ds_write_b32 v9, v10
L_g2_nl:
    s_mov_b32 s66, 0
Lf46:
    buffer_load_dword v20, v125, s[40:43], s48 offen sc1
    s_add_u32 s66, s66, 1
    s_cmp_le_u32 s66, 48
    s_cbranch_scc1 Lf46a
    buffer_load_dword v21, v126, s[40:43], s48 offen sc1
    s_waitcnt vmcnt(0)
    v_cmp_eq_u32 vcc, s52, v21
    s_nop 1
    v_cndmask_b32 v20, v20, v21, vcc
Lf46a:
    s_waitcnt vmcnt(0)
    v_cmp_ne_u32 vcc, s52, v20
    s_nop 0
    s_cbranch_vccz Lf46d
    s_sleep 2
    s_sub_u32 s55, s55, 1
    s_max_i32 s55, s55, 0
    s_cmp_lg_u32 s55, 0
    s_cbranch_scc1 Lf46
Lf46d:
    s_setprio 0
    v_mov_b32 v113, 3
    buffer_load_dwordx4 v[184:187], v121, s[40:43], s101 offen offset:0 sc1
    buffer_load_dwordx4 v[188:191], v121, s[40:43], s101 offen offset:1024 sc1
    buffer_load_dwordx4 v[192:195], v121, s[40:43], s101 offen offset:2048 sc1
    buffer_load_dwordx4 v[196:199], v121, s[40:43], s101 offen offset:3072 sc1
    s_add_u32 s101, s101, 4096
    buffer_load_dwordx4 v[200:203], v121, s[40:43], s101 offen offset:0 sc1
    buffer_load_dwordx4 v[204:207], v121, s[40:43], s101 offen offset:1024 sc1
    buffer_load_dwordx4 v[208:211], v121, s[40:43], s101 offen offset:2048 sc1
    buffer_load_dwordx4 v[212:215], v121, s[40:43], s101 offen offset:3072 sc1
    s_add_u32 s101, s101, 4096
    buffer_load_dwordx4 v[216:219], v121, s[40:43], s101 offen offset:0 sc1
    buffer_load_dwordx4 v[220:223], v121, s[40:43], s101 offen offset:1024 sc1
    buffer_load_dwordx4 v[224:227], v121, s[40:43], s101 offen offset:2048 sc1
    buffer_load_dwordx4 v[228:231], v121, s[40:43], s101 offen offset:3072 sc1
    s_add_u32 s101, s101, 4096
    ds_read_b32 v16, v120 offset:0
    s_waitcnt vmcnt(11)
    v_mfma_f32_32x32x16_bf16 v[152:167], v[32:35], v[184:187], 0
    v_mfma_f32_32x32x16_bf16 v[168:183], v[36:39], v[184:187], 0
    buffer_load_dwordx4 v[232:235], v121, s[40:43], s101 offen offset:0 sc1
    s_waitcnt vmcnt(11)
    v_mfma_f32_32x32x16_bf16 v[152:167], v[40:43], v[188:191], v[152:167]
    v_mfma_f32_32x32x16_bf16 v[168:183], v[44:47], v[188:191], v[168:183]
    buffer_load_dwordx4 v[236:239], v121, s[40:43], s101 offen offset:1024 sc1
    s_waitcnt vmcnt(11)
    v_mfma_f32_32x32x16_bf16 v[152:167], v[48:51], v[192:195], v[152:167]
    v_mfma_f32_32x32x16_bf16 v[168:183], v[52:55], v[192:195], v[168:183]
    buffer_load_dwordx4 v[240:243], v121, s[40:43], s101 offen offset:2048 sc1
    s_waitcnt vmcnt(11)
    v_mfma_f32_32x32x16_bf16 v[152:167], v[56:59], v[196:199], v[152:167]
    v_mfma_f32_32x32x16_bf16 v[168:183], v[60:63], v[196:199], v[168:183]
    buffer_load_dwordx4 v[244:247], v121, s[40:43], s101 offen offset:3072 sc1
    s_add_u32 s101, s101, 4096
    s_waitcnt vmcnt(11)
    v_mfma_f32_32x32x16_bf16 v[152:167], v[64:67], v[200:203], v[152:167]
    v_mfma_f32_32x32x16_bf16 v[168:183], v[68:71], v[200:203], v[168:183]
    buffer_load_dwordx4 v[248:251], v121, s[40:43], s101 offen offset:0 sc1
    s_waitcnt vmcnt(11)
    v_mfma_f32_32x32x16_bf16 v[152:167], v[72:75], v[204:207], v[152:167]
    v_mfma_f32_32x32x16_bf16 v[168:183], v[76:79], v[204:207], v[168:183]
    buffer_load_dwordx4 v[252:255], v121, s[40:43], s101 offen offset:1024 sc1
    s_waitcnt vmcnt(11)
    v_mfma_f32_32x32x16_bf16 v[152:167], v[80:83], v[208:211], v[152:167]
    v_mfma_f32_32x32x16_bf16 v[168:183], v[84:87], v[208:211], v[168:183]
    buffer_load_dwordx4 v[184:187], v121, s[40:43], s101 offen offset:2048 sc1
    s_waitcnt vmcnt(11)
    v_mfma_f32_32x32x16_bf16 v[152:167], v[88:91], v[212:215], v[152:167]
    v_mfma_f32_32x32x16_bf16 v[168:183], v[92:95], v[212:215], v[168:183]
    buffer_load_dwordx4 v[188:191], v121, s[40:43], s101 offen offset:3072 sc1
    s_add_u32 s101, s101, 4096
    s_waitcnt vmcnt(11)
    v_mfma_f32_32x32x16_bf16 v[152:167], v[96:99], v[216:219], v[152:167]
    v_mfma_f32_32x32x16_bf16 v[168:183], v[100:103], v[216:219], v[168:183]
    buffer_load_dwordx4 v[192:195], v121, s[40:43], s101 offen offset:0 sc1
    s_waitcnt vmcnt(11)
    v_mfma_f32_32x32x16_bf16 v[152:167], v[104:107], v[220:223], v[152:167]
    v_mfma_f32_32x32x16_bf16 v[168:183], v[108:111], v[220:223], v[168:183]
    buffer_load_dwordx4 v[196:199], v121, s[40:43], s101 offen offset:1024 sc1
    s_waitcnt vmcnt(11)
    v_mfma_f32_32x32x16_bf16 v[152:167], v[128:131], v[224:227], v[152:167]
    ds_read_b64_tr_b16 v[32:33], v116 offset:6144
    ds_read_b64_tr_b16 v[34:35], v116 offset:6656
    ds_read_b64_tr_b16 v[36:37], v117 offset:6144
    v_mfma_f32_32x32x16_bf16 v[168:183], v[132:135], v[224:227], v[168:183]
    ds_read_b64_tr_b16 v[38:39], v117 offset:6656
    buffer_load_dwordx4 v[200:203], v121, s[40:43], s101 offen offset:2048 sc1
    s_waitcnt vmcnt(11)
    v_mfma_f32_32x32x16_bf16 v[152:167], v[136:139], v[228:231], v[152:167]
    ds_read_b64_tr_b16 v[40:41], v116 offset:8192
    ds_read_b64_tr_b16 v[42:43], v116 offset:8704
    ds_read_b64_tr_b16 v[44:45], v117 offset:8192
    v_mfma_f32_32x32x16_bf16 v[168:183], v[140:143], v[228:231], v[168:183]
    ds_read_b64_tr_b16 v[46:47], v117 offset:8704
    buffer_load_dwordx4 v[204:207], v121, s[40:43], s101 offen offset:3072 sc1
    s_add_u32 s101, s101, 4096
    s_waitcnt vmcnt(11)
    v_mfma_f32_32x32x16_bf16 v[152:167], v[144:147], v[232:235], v[152:167]
    ds_read_b64_tr_b16 v[48:49], v116 offset:10240
    ds_read_b64_tr_b16 v[50:51], v116 offset:10752
    ds_read_b64_tr_b16 v[52:53], v117 offset:10240
    v_mfma_f32_32x32x16_bf16 v[168:183], v[148:151], v[232:235], v[168:183]
    ds_read_b64_tr_b16 v[54:55], v117 offset:10752
    buffer_load_dwordx4 v[208:211], v121, s[40:43], s101 offen offset:0 sc1
    s_waitcnt vmcnt(11) lgkmcnt(8)
    v_mfma_f32_32x32x16_bf16 v[152:167], v[32:35], v[236:239], v[152:167]
    ds_read_b64_tr_b16 v[56:57], v116 offset:12288
    ds_read_b64_tr_b16 v[58:59], v116 offset:12800
    ds_read_b64_tr_b16 v[60:61], v117 offset:12288
    v_mfma_f32_32x32x16_bf16 v[168:183], v[36:39], v[236:239], v[168:183]
    ds_read_b64_tr_b16 v[62:63], v117 offset:12800
    buffer_load_dwordx4 v[212:215], v121, s[40:43], s101 offen offset:1024 sc1
    s_waitcnt vmcnt(11) lgkmcnt(8)
    v_mfma_f32_32x32x16_bf16 v[152:167], v[40:43], v[240:243], v[152:167]
    ds_read_b64_tr_b16 v[64:65], v116 offset:14336
    ds_read_b64_tr_b16 v[66:67], v116 offset:14848
    ds_read_b64_tr_b16 v[68:69], v117 offset:14336
    v_mfma_f32_32x32x16_bf16 v[168:183], v[44:47], v[240:243], v[168:183]
    ds_read_b64_tr_b16 v[70:71], v117 offset:14848
    buffer_load_dwordx4 v[216:219], v121, s[40:43], s101 offen offset:2048 sc1
    s_waitcnt vmcnt(11) lgkmcnt(8)
    v_mfma_f32_32x32x16_bf16 v[152:167], v[48:51], v[244:247], v[152:167]
    ds_read_b64_tr_b16 v[72:73], v116 offset:16384
    ds_read_b64_tr_b16 v[74:75], v116 offset:16896
    ds_read_b64_tr_b16 v[76:77], v117 offset:16384
    v_mfma_f32_32x32x16_bf16 v[168:183], v[52:55], v[244:247], v[168:183]
    ds_read_b64_tr_b16 v[78:79], v117 offset:16896
    buffer_load_dwordx4 v[220:223], v121, s[40:43], s101 offen offset:3072 sc1
    s_add_u32 s101, s101, 4096
    s_waitcnt vmcnt(11) lgkmcnt(8)
    v_mfma_f32_32x32x16_bf16 v[152:167], v[56:59], v[248:251], v[152:167]
    ds_read_b64_tr_b16 v[80:81], v116 offset:18432
    ds_read_b64_tr_b16 v[82:83], v116 offset:18944
    ds_read_b64_tr_b16 v[84:85], v117 offset:18432
    v_mfma_f32_32x32x16_bf16 v[168:183], v[60:63], v[248:251], v[168:183]
    ds_read_b64_tr_b16 v[86:87], v117 offset:18944
    buffer_load_dwordx4 v[224:227], v121, s[40:43], s101 offen offset:0 sc1
    s_waitcnt vmcnt(11) lgkmcnt(8)
Lv47:
    s_waitcnt lgkmcnt(0)
    v_cmp_gt_u32 vcc, 13, v16
    s_nop 0
    s_cbranch_vccz Lv47d
    ds_read_b32 v16, v120 offset:0
    s_sub_u32 s55, s55, 1
    s_max_i32 s55, s55, 0
    s_cmp_lg_u32 s55, 0
    s_cbranch_scc1 Lv47
Lv47d:
    v_mfma_f32_32x32x16_bf16 v[152:167], v[64:67], v[252:255], v[152:167]
    ds_read_b64_tr_b16 v[88:89], v116 offset:40960
    ds_read_b64_tr_b16 v[90:91], v116 offset:41472
    ds_read_b64_tr_b16 v[92:93], v117 offset:40960
    v_mfma_f32_32x32x16_bf16 v[168:183], v[68:71], v[252:255], v[168:183]
    ds_read_b64_tr_b16 v[94:95], v117 offset:41472
    buffer_load_dwordx4 v[228:231], v121, s[40:43], s101 offen offset:1024 sc1
    s_waitcnt vmcnt(11)
    v_mfma_f32_32x32x16_bf16 v[152:167], v[72:75], v[184:187], v[152:167]
    ds_read_b64_tr_b16 v[96:97], v116 offset:43008
    ds_read_b64_tr_b16 v[98:99], v116 offset:43520
    ds_read_b64_tr_b16 v[100:101], v117 offset:43008
    v_mfma_f32_32x32x16_bf16 v[168:183], v[76:79], v[184:187], v[168:183]
    ds_read_b64_tr_b16 v[102:103], v117 offset:43520
    buffer_load_dwordx4 v[232:235], v121, s[40:43], s101 offen offset:2048 sc1
    s_waitcnt vmcnt(11)
    v_mfma_f32_32x32x16_bf16 v[152:167], v[80:83], v[188:191], v[152:167]
    ds_read_b64_tr_b16 v[104:105], v116 offset:45056
    ds_read_b64_tr_b16 v[106:107], v116 offset:45568
    ds_read_b64_tr_b16 v[108:109], v117 offset:45056
    v_mfma_f32_32x32x16_bf16 v[168:183], v[84:87], v[188:191], v[168:183]
    ds_read_b64_tr_b16 v[110:111], v117 offset:45568
    buffer_load_dwordx4 v[236:239], v121, s[40:43], s101 offen offset:3072 sc1
    s_add_u32 s101, s101, 4096
    s_waitcnt vmcnt(11) lgkmcnt(8)
    v_mfma_f32_32x32x16_bf16 v[152:167], v[88:91], v[192:195], v[152:167]
    ds_read_b64_tr_b16 v[128:129], v116 offset:47104
    ds_read_b64_tr_b16 v[130:131], v116 offset:47616
    ds_read_b64_tr_b16 v[132:133], v117 offset:47104
    v_mfma_f32_32x32x16_bf16 v[168:183], v[92:95], v[192:195], v[168:183]
    ds_read_b64_tr_b16 v[134:135], v117 offset:47616
    buffer_load_dwordx4 v[240:243], v121, s[40:43], s101 offen offset:0 sc1
    s_waitcnt vmcnt(11) lgkmcnt(8)
    v_mfma_f32_32x32x16_bf16 v[152:167], v[96:99], v[196:199], v[152:167]
    ds_read_b64_tr_b16 v[136:137], v116 offset:49152
    ds_read_b64_tr_b16 v[138:139], v116 offset:49664
    ds_read_b64_tr_b16 v[140:141], v117 offset:49152
    v_mfma_f32_32x32x16_bf16 v[168:183], v[100:103], v[196:199], v[168:183]
    ds_read_b64_tr_b16 v[142:143], v117 offset:49664
    buffer_load_dwordx4 v[244:247], v121, s[40:43], s101 offen offset:1024 sc1
    s_waitcnt vmcnt(11) lgkmcnt(8)
    v_mfma_f32_32x32x16_bf16 v[152:167], v[104:107], v[200:203], v[152:167]
    ds_read_b64_tr_b16 v[144:145], v116 offset:51200
    ds_read_b64_tr_b16 v[146:147], v116 offset:51712
    ds_read_b64_tr_b16 v[148:149], v117 offset:51200
    v_mfma_f32_32x32x16_bf16 v[168:183], v[108:111], v[200:203], v[168:183]
    ds_read_b64_tr_b16 v[150:151], v117 offset:51712
    buffer_load_dwordx4 v[248:251], v121, s[40:43], s101 offen offset:2048 sc1
    s_waitcnt vmcnt(11) lgkmcnt(8)
    v_mfma_f32_32x32x16_bf16 v[152:167], v[128:131], v[204:207], v[152:167]
    ds_read_b64_tr_b16 v[32:33], v116 offset:53248
    ds_read_b64_tr_b16 v[34:35], v116 offset:53760
    ds_read_b64_tr_b16 v[36:37], v117 offset:53248
    v_mfma_f32_32x32x16_bf16 v[168:183], v[132:135], v[204:207], v[168:183]
    ds_read_b64_tr_b16 v[38:39], v117 offset:53760
    buffer_load_dwordx4 v[252:255], v121, s[40:43], s101 offen offset:3072 sc1
    s_add_u32 s101, s101, 4096
    s_waitcnt vmcnt(11) lgkmcnt(8)
    v_mfma_f32_32x32x16_bf16 v[152:167], v[136:139], v[208:211], v[152:167]
    ds_read_b64_tr_b16 v[40:41], v116 offset:55296
    ds_read_b64_tr_b16 v[42:43], v116 offset:55808
    ds_read_b64_tr_b16 v[44:45], v117 offset:55296
    v_mfma_f32_32x32x16_bf16 v[168:183], v[140:143], v[208:211], v[168:183]
    ds_read_b64_tr_b16 v[46:47], v117 offset:55808
    buffer_load_dwordx4 v[184:187], v121, s[40:43], s101 offen offset:0 sc1
    s_waitcnt vmcnt(11) lgkmcnt(8)
    v_mfma_f32_32x32x16_bf16 v[152:167], v[144:147], v[212:215], v[152:167]
    ds_read_b64_tr_b16 v[48:49], v116 offset:57344
    ds_read_b64_tr_b16 v[50:51], v116 offset:57856
    ds_read_b64_tr_b16 v[52:53], v117 offset:57344
    v_mfma_f32_32x32x16_bf16 v[168:183], v[148:151], v[212:215], v[168:183]
    ds_read_b64_tr_b16 v[54:55], v117 offset:57856
    buffer_load_dwordx4 v[188:191], v121, s[40:43], s101 offen offset:1024 sc1
    ds_write_b32 v122, v114 offset:176
    s_waitcnt vmcnt(11) lgkmcnt(9)
    v_mfma_f32_32x32x16_bf16 v[152:167], v[32:35], v[216:219], v[152:167]
    ds_read_b64_tr_b16 v[56:57], v116 offset:59392
    ds_read_b64_tr_b16 v[58:59], v116 offset:59904
    ds_read_b64_tr_b16 v[60:61], v117 offset:59392
    v_mfma_f32_32x32x16_bf16 v[168:183], v[36:39], v[216:219], v[168:183]
    ds_read_b64_tr_b16 v[62:63], v117 offset:59904
    buffer_load_dwordx4 v[192:195], v121, s[40:43], s101 offen offset:2048 sc1
    s_waitcnt vmcnt(11) lgkmcnt(9)
    v_mfma_f32_32x32x16_bf16 v[152:167], v[40:43], v[220:223], v[152:167]
    ds_read_b64_tr_b16 v[64:65], v118 offset:0
    ds_read_b64_tr_b16 v[66:67], v118 offset:512
    ds_read_b64_tr_b16 v[68:69], v119 offset:0
    v_mfma_f32_32x32x16_bf16 v[168:183], v[44:47], v[220:223], v[168:183]
    ds_read_b64_tr_b16 v[70:71], v119 offset:512
    buffer_load_dwordx4 v[196:199], v121, s[40:43], s101 offen offset:3072 sc1
    s_add_u32 s101, s101, 4096
    s_waitcnt vmcnt(11) lgkmcnt(9)
    v_mfma_f32_32x32x16_bf16 v[152:167], v[48:51], v[224:227], v[152:167]
    ds_read_b64_tr_b16 v[72:73], v118 offset:2048
    ds_read_b64_tr_b16 v[74:75], v118 offset:2560
    ds_read_b64_tr_b16 v[76:77], v119 offset:2048
    v_mfma_f32_32x32x16_bf16 v[168:183], v[52:55], v[224:227], v[168:183]
    ds_read_b64_tr_b16 v[78:79], v119 offset:2560
    buffer_load_dwordx4 v[200:203], v121, s[40:43], s101 offen offset:0 sc1
    s_waitcnt vmcnt(11) lgkmcnt(8)
    v_mfma_f32_32x32x16_bf16 v[152:167], v[56:59], v[228:231], v[152:167]
    ds_read_b64_tr_b16 v[80:81], v118 offset:4096
    ds_read_b64_tr_b16 v[82:83], v118 offset:4608
    ds_read_b64_tr_b16 v[84:85], v119 offset:4096
    v_mfma_f32_32x32x16_bf16 v[168:183], v[60:63], v[228:231], v[168:183]
    ds_read_b64_tr_b16 v[86:87], v119 offset:4608
    buffer_load_dwordx4 v[204:207], v121, s[40:43], s101 offen offset:1024 sc1
    s_waitcnt vmcnt(11) lgkmcnt(8)
    v_mfma_f32_32x32x16_bf16 v[152:167], v[64:67], v[232:235], v[152:167]
    ds_read_b64_tr_b16 v[88:89], v118 offset:6144
    ds_read_b64_tr_b16 v[90:91], v118 offset:6656
    ds_read_b64_tr_b16 v[92:93], v119 offset:6144
    v_mfma_f32_32x32x16_bf16 v[168:183], v[68:71], v[232:235], v[168:183]
    ds_read_b64_tr_b16 v[94:95], v119 offset:6656
    buffer_load_dwordx4 v[208:211], v121, s[40:43], s101 offen offset:2048 sc1
    ds_write_b32 v122, v115 offset:176
    s_waitcnt vmcnt(11) lgkmcnt(9)
    v_mfma_f32_32x32x16_bf16 v[152:167], v[72:75], v[236:239], v[152:167]
    ds_read_b64_tr_b16 v[96:97], v118 offset:8192
    ds_read_b64_tr_b16 v[98:99], v118 offset:8704
    ds_read_b64_tr_b16 v[100:101], v119 offset:8192
    v_mfma_f32_32x32x16_bf16 v[168:183], v[76:79], v[236:239], v[168:183]
    ds_read_b64_tr_b16 v[102:103], v119 offset:8704
    s_waitcnt vmcnt(10) lgkmcnt(9)
    v_mfma_f32_32x32x16_bf16 v[152:167], v[80:83], v[240:243], v[152:167]
    ds_read_b64_tr_b16 v[104:105], v118 offset:10240
    ds_read_b64_tr_b16 v[106:107], v118 offset:10752
    ds_read_b64_tr_b16 v[108:109], v119 offset:10240
    v_mfma_f32_32x32x16_bf16 v[168:183], v[84:87], v[240:243], v[168:183]
    ds_read_b64_tr_b16 v[110:111], v119 offset:10752
    s_waitcnt vmcnt(9) lgkmcnt(9)
    v_mfma_f32_32x32x16_bf16 v[152:167], v[88:91], v[244:247], v[152:167]
    ds_read_b64_tr_b16 v[128:129], v118 offset:12288
    ds_read_b64_tr_b16 v[130:131], v118 offset:12800
    ds_read_b64_tr_b16 v[132:133], v119 offset:12288
    v_mfma_f32_32x32x16_bf16 v[168:183], v[92:95], v[244:247], v[168:183]
    ds_read_b64_tr_b16 v[134:135], v119 offset:12800
    s_waitcnt vmcnt(8) lgkmcnt(8)
    v_mfma_f32_32x32x16_bf16 v[152:167], v[96:99], v[248:251], v[152:167]
    ds_read_b64_tr_b16 v[136:137], v118 offset:14336
    ds_read_b64_tr_b16 v[138:139], v118 offset:14848
    ds_read_b64_tr_b16 v[140:141], v119 offset:14336
    v_mfma_f32_32x32x16_bf16 v[168:183], v[100:103], v[248:251], v[168:183]
    ds_read_b64_tr_b16 v[142:143], v119 offset:14848
    s_waitcnt vmcnt(7) lgkmcnt(8)
    v_mfma_f32_32x32x16_bf16 v[152:167], v[104:107], v[252:255], v[152:167]
    ds_read_b64_tr_b16 v[144:145], v118 offset:16384
    ds_read_b64_tr_b16 v[146:147], v118 offset:16896
    ds_read_b64_tr_b16 v[148:149], v119 offset:16384
    v_mfma_f32_32x32x16_bf16 v[168:183], v[108:111], v[252:255], v[168:183]
    ds_read_b64_tr_b16 v[150:151], v119 offset:16896
    s_waitcnt vmcnt(6) lgkmcnt(8)
    v_mfma_f32_32x32x16_bf16 v[152:167], v[128:131], v[184:187], v[152:167]
    ds_read_b64_tr_b16 v[32:33], v118 offset:18432
    ds_read_b64_tr_b16 v[34:35], v118 offset:18944
    ds_read_b64_tr_b16 v[36:37], v119 offset:18432
    v_mfma_f32_32x32x16_bf16 v[168:183], v[132:135], v[184:187], v[168:183]
    ds_read_b64_tr_b16 v[38:39], v119 offset:18944
    s_waitcnt vmcnt(5) lgkmcnt(8)
    v_mfma_f32_32x32x16_bf16 v[152:167], v[136:139], v[188:191], v[152:167]
    ds_read_b64_tr_b16 v[40:41], v116 offset:0
    ds_read_b64_tr_b16 v[42:43], v116 offset:512
    ds_read_b64_tr_b16 v[44:45], v117 offset:0
    v_mfma_f32_32x32x16_bf16 v[168:183], v[140:143], v[188:191], v[168:183]
    ds_read_b64_tr_b16 v[46:47], v117 offset:512
    s_waitcnt vmcnt(4) lgkmcnt(8)
    v_mfma_f32_32x32x16_bf16 v[152:167], v[144:147], v[192:195], v[152:167]
    ds_read_b64_tr_b16 v[48:49], v116 offset:2048
    ds_read_b64_tr_b16 v[50:51], v116 offset:2560
    ds_read_b64_tr_b16 v[52:53], v117 offset:2048
    v_mfma_f32_32x32x16_bf16 v[168:183], v[148:151], v[192:195], v[168:183]
    ds_read_b64_tr_b16 v[54:55], v117 offset:2560
    s_waitcnt vmcnt(3) lgkmcnt(8)
    v_mfma_f32_32x32x16_bf16 v[152:167], v[32:35], v[196:199], v[152:167]
    ds_read_b64_tr_b16 v[56:57], v116 offset:4096
    ds_read_b64_tr_b16 v[58:59], v116 offset:4608
    ds_read_b64_tr_b16 v[60:61], v117 offset:4096
    v_mfma_f32_32x32x16_bf16 v[168:183], v[36:39], v[196:199], v[168:183]
    ds_read_b64_tr_b16 v[62:63], v117 offset:4608
    s_waitcnt vmcnt(2) lgkmcnt(8)
    v_mfma_f32_32x32x16_bf16 v[152:167], v[40:43], v[200:203], v[152:167]
    v_mfma_f32_32x32x16_bf16 v[168:183], v[44:47], v[200:203], v[168:183]
    s_waitcnt vmcnt(1) lgkmcnt(4)
    v_mfma_f32_32x32x16_bf16 v[152:167], v[48:51], v[204:207], v[152:167]
    v_mfma_f32_32x32x16_bf16 v[168:183], v[52:55], v[204:207], v[168:183]
    ds_read_b32 v16, v123 offset:176
    s_waitcnt vmcnt(0) lgkmcnt(1)
    v_mfma_f32_32x32x16_bf16 v[152:167], v[56:59], v[208:211], v[152:167]
    v_mfma_f32_32x32x16_bf16 v[168:183], v[60:63], v[208:211], v[168:183]
Lv48:
    s_waitcnt lgkmcnt(0)
    v_cmp_gt_u32 vcc, 2, v16
    s_nop 0
    s_cbranch_vccz Lv48d
    ds_read_b32 v16, v123 offset:176
    s_sub_u32 s55, s55, 1
    s_max_i32 s55, s55, 0
    s_cmp_lg_u32 s55, 0
    s_cbranch_scc1 Lv48
Lv48d:
    s_nop 6
    ds_write_b128 v124, v[152:155] offset:0
    ds_write_b128 v124, v[156:159] offset:1024
    ds_write_b128 v124, v[160:163] offset:2048
    ds_write_b128 v124, v[164:167] offset:3072
    ds_write_b128 v124, v[168:171] offset:4096
    ds_write_b128 v124, v[172:175] offset:5120
    ds_write_b128 v124, v[176:179] offset:6144
    ds_write_b128 v124, v[180:183] offset:7168
    s_waitcnt lgkmcnt(0)
    ds_write_b32 v122, v114 offset:192
    s_waitcnt lgkmcnt(0)
    s_endpgm
L_exit:
    s_endpgm
L_codeend:
.section .rodata,"a"
.p2align 6
.amdhsa_kernel recurrent_scan__ssm_conv_s4d__swiglu_ffn__prompt_kernel
  .amdhsa_next_free_vgpr 256
  .amdhsa_next_free_sgpr 102
  .amdhsa_accum_offset 256
  .amdhsa_group_segment_fixed_size 0
  .amdhsa_kernarg_size 112
  .amdhsa_user_sgpr_count 2
  .amdhsa_user_sgpr_kernarg_segment_ptr 1
  .amdhsa_system_sgpr_workgroup_id_x 1
  .amdhsa_float_denorm_mode_32 3
.end_amdhsa_kernel
```
